```python
import torch

def _softmax(x, axis=-1):
    return torch.softmax(x, dim=axis)
def _gelu(x):
    return torch.nn.functional.gelu(x, approximate="tanh")
def _silu(x):
    return torch.nn.functional.silu(x)
def _sigmoid(x):
    return torch.sigmoid(x)
def _layernorm(x, axis=-1, eps=1e-5):
    m = x.mean(dim=axis, keepdim=True)
    v = x.var(dim=axis, keepdim=True, unbiased=False)
    return (x - m) / torch.sqrt(v + eps)
def _scatter_add(tgt, idx, src, axis=0):
    return tgt.clone().index_add_(axis, idx, src)
def _segment_sum(src, seg, n):
    out = torch.zeros((n,) + src.shape[1:], dtype=src.dtype)
    return out.index_add_(0, seg, src)
def _pad(x, pw):
    flat = tuple(v for pair in reversed(pw) for v in pair)
    return torch.nn.functional.pad(x, flat)

kernel_name = 'concat_heads__gqa_block_cached__mha_block_cached__near_ridge'

def setup_inputs():

    _w = (lambda a: (lambda t: t.to(torch.bfloat16) if t.is_floating_point() else t)(torch.as_tensor(a)))
    def _A_setup():
        B, Sq, D = 16, 32, 576
        Hq, Hkv, Sk, Dh = 32, 16, 32, 128
        assert Hq % Hkv == 0, (Hq, Hkv)
        return {
            "x": _w((lambda *s: torch.randn(*s, dtype=torch.bfloat16) * 0.8)(B, Sq, D)),
            "k_cache": _w((lambda *s: torch.randn(*s, dtype=torch.bfloat16) * 0.8)(B, Hkv, Sk, Dh)),
            "v_cache": _w((lambda *s: torch.randn(*s, dtype=torch.bfloat16) * 0.05)(B, Hkv, Sk, Dh)),
            "wq": _w((lambda *s: torch.randn(*s, dtype=torch.bfloat16) * 0.8)(D, Hq * Dh) * (D ** -0.5)),
            "wo": _w((lambda *s: torch.randn(*s, dtype=torch.bfloat16) * 0.05)(Hq * Dh, D) * ((Hq * Dh) ** -0.5)),
        }
    _A_in = _A_setup()

    def _B_setup():
        B, Sq, D = 16, 32, 576
        H, Sk, Dh = 32, 32, 128
        return {
            "x": _w((lambda *s: torch.randn(*s, dtype=torch.bfloat16) * 0.8)(B, Sq, D)),
            "k_cache": _w((lambda *s: torch.randn(*s, dtype=torch.bfloat16) * 0.8)(B, H, Sk, Dh)),
            "v_cache": _w((lambda *s: torch.randn(*s, dtype=torch.bfloat16) * 0.05)(B, H, Sk, Dh)),
            "wq": _w((lambda *s: torch.randn(*s, dtype=torch.bfloat16) * 0.8)(D, H * Dh) * (D ** -0.5)),
            "wo": _w((lambda *s: torch.randn(*s, dtype=torch.bfloat16) * 0.05)(H * Dh, D) * ((H * Dh) ** -0.5)),
        }
    _B_in = _B_setup()

    return {
        "A_x": _A_in["x"],
        "A_k_cache": _A_in["k_cache"],
        "A_v_cache": _A_in["v_cache"],
        "A_wq": _A_in["wq"],
        "A_wo": _A_in["wo"],
        "B_x": _B_in["x"],
        "B_k_cache": _B_in["k_cache"],
        "B_v_cache": _B_in["v_cache"],
        "B_wq": _B_in["wq"],
        "B_wo": _B_in["wo"],
    }

def reference(A_x, A_k_cache, A_v_cache, A_wq, A_wo, B_x, B_k_cache, B_v_cache, B_wq, B_wo):
    def _A_ref(x, k_cache, v_cache, wq, wo):
        B, Sq, D = x.shape
        Hq, Dh = 32, 128
        Hkv = k_cache.shape[1]
        rep = Hq // Hkv
        q = (lambda x, *d: x.permute(*d))((x @ wq).reshape(B, Sq, Hq, Dh), 0, 2, 1, 3)
        k = (lambda x, n, axis: torch.repeat_interleave(x, n, dim=axis))(k_cache, rep, axis=1)
        v = (lambda x, n, axis: torch.repeat_interleave(x, n, dim=axis))(v_cache, rep, axis=1)
        scores = torch.einsum("bhqd,bhkd->bhqk", q, k) * (Dh ** -0.5)
        p = _softmax(scores, axis=-1)
        o = torch.einsum("bhqk,bhkd->bhqd", p, v)
        return (lambda x, *d: x.permute(*d))(o, 0, 2, 1, 3).reshape(B, Sq, Hq * Dh) @ wo

    def _B_ref(x, k_cache, v_cache, wq, wo):
        B, Sq, D = x.shape
        H, Dh = 32, 128
        q = (lambda x, *d: x.permute(*d))((x @ wq).reshape(B, Sq, H, Dh), 0, 2, 1, 3)
        scores = torch.einsum("bhqd,bhkd->bhqk", q, k_cache) * (Dh ** -0.5)
        p = _softmax(scores, axis=-1)
        o = torch.einsum("bhqk,bhkd->bhqd", p, v_cache)
        return (lambda x, *d: x.permute(*d))(o, 0, 2, 1, 3).reshape(B, Sq, H * Dh) @ wo

    a = _A_ref(A_x, A_k_cache, A_v_cache, A_wq, A_wo)
    b = _B_ref(B_x, B_k_cache, B_v_cache, B_wq, B_wo)
    return torch.concatenate([a, b], axis=-1)
```

```asm
; @launch grid=(256,1,1) block=(512,1,1) lds=163840
.amdgcn_target "amdgcn-amd-amdhsa--gfx950"
.text
.globl concat_heads__gqa_block_cached__mha_block_cached__near_ridge_kernel
.p2align 12
.p2align 8
.type concat_heads__gqa_block_cached__mha_block_cached__near_ridge_kernel,@function
concat_heads__gqa_block_cached__mha_block_cached__near_ridge_kernel:
s_cmp_ge_u32 s2, 256
s_cbranch_scc1 L_end
s_lshr_b32 s4, s2, 7
s_xor_b32 s4, s4, 1
s_mul_i32 s44, s4, 40
s_add_u32 s44, s0, s44
s_addc_u32 s45, s1, 0
s_load_dwordx2 s[12:13], s[44:45], 0
s_load_dwordx2 s[24:25], s[44:45], 24
s_load_dwordx2 s[16:17], s[44:45], 8
s_load_dwordx2 s[20:21], s[44:45], 16
s_load_dwordx2 s[28:29], s[44:45], 32
s_load_dwordx2 s[40:41], s[0:1], 96
s_load_dwordx2 s[32:33], s[0:1], 80
s_load_dwordx2 s[36:37], s[0:1], 88
v_lshrrev_b32 v1, 6, v0
s_bfe_u32 s5, s2, 0x20003
s_bfe_u32 s46, s2, 0x20005
s_and_b32 s6, s2, 7
s_lshl_b32 s6, s6, 2
s_add_u32 s6, s6, s46
v_readfirstlane_b32 s3, v1
v_and_b32 v0, 63, v0
s_and_b32 s9, s3, 3
s_mov_b32 s14, 589824
s_mov_b32 s15, 0x00020000
s_mov_b32 s26, 4718592
s_mov_b32 s27, 0x00020000
s_mov_b32 s42, 268435456
s_mov_b32 s43, 0x00020000
s_cmp_lt_u32 s3, 4
s_cbranch_scc1 L_compute
v_lshrrev_b32 v28, 3, v0
v_and_b32 v29, 7, v0
v_lshrrev_b32 v30, 4, v0
v_and_b32 v31, 15, v0
s_movk_i32 s45, 1152
v_xor_b32 v32, v29, v30
v_lshlrev_b32 v32, 4, v32
v_mad_u32_u24 v2, v28, s45, v32
v_lshlrev_b32 v35, 2, v30
v_xor_b32 v35, v35, v31
v_lshlrev_b32 v35, 4, v35
v_lshl_or_b32 v10, v30, 13, v35
v_xor_b32 v39, 64, v2
v_add_u32 v3, 8192, v39
v_add_u32 v11, 31744, v10
v_add_u32 v4, 16384, v2
v_add_u32 v12, 63488, v10
v_add_u32 v5, 24576, v39
v_add_u32 v13, 95232, v10
s_lshl_b32 s52, s5, 2
s_add_u32 s52, s52, s9
s_mul_i32 s50, s52, 36864
s_lshl_b32 s51, s9, 17
s_lshl_b32 s44, s6, 8
s_add_u32 s51, s51, s44
s_lshl_b32 s53, s9, 12
s_lshl_b32 s54, s5, 1
s_cmp_ge_u32 s54, 9
s_cselect_b32 s44, 9, 0
s_sub_u32 s54, s54, s44
s_lshl_b32 s55, s5, 1
s_add_u32 s55, s55, s46
s_cmp_ge_u32 s55, 9
s_cselect_b32 s44, 9, 0
s_sub_u32 s55, s55, s44
s_cmp_eq_u32 s4, 0
s_cselect_b32 s54, s54, s55
s_waitcnt lgkmcnt(0)
s_cmp_eq_u32 s4, 1
s_cbranch_scc1 L_k0
s_sub_u32 s10, 1, s4
s_add_u32 s11, s4, 17
s_lshl_b32 s52, s52, s11
s_lshl_b32 s18, 0x200000, s4
s_mov_b32 s19, 0x00020000
v_lshl_or_b32 v6, v28, 8, v32
v_xor_b32 v38, 64, v6
v_add_u32 v7, 1024, v38
v_add_u32 v8, 2048, v6
v_add_u32 v9, 3072, v38
s_lshr_b32 s44, s6, s10
s_lshl_b32 s44, s44, 13
s_add_u32 s44, s44, s52
s_add_u32 m0, s53, 131072
s_add_u32 s45, s44, 128
buffer_load_dwordx4 v6, s[16:19], s44 offen offset:0 lds
buffer_load_dwordx4 v7, s[16:19], s44 offen offset:1024 lds
buffer_load_dwordx4 v8, s[16:19], s44 offen offset:2048 lds
buffer_load_dwordx4 v9, s[16:19], s44 offen offset:3072 lds
s_add_u32 m0, s53, 147456
s_nop 0
buffer_load_dwordx4 v6, s[16:19], s45 offen offset:0 lds
buffer_load_dwordx4 v7, s[16:19], s45 offen offset:1024 lds
buffer_load_dwordx4 v8, s[16:19], s45 offen offset:2048 lds
buffer_load_dwordx4 v9, s[16:19], s45 offen offset:3072 lds
s_lshl_b32 s44, s54, 7
s_add_u32 m0, s53, 0
s_add_u32 s44, s44, s50
s_lshl_b32 s45, s54, 19
s_add_u32 s45, s45, s51
buffer_load_dwordx4 v2, s[12:15], s44 offen offset:0 lds
buffer_load_dwordx4 v3, s[12:15], s44 offen offset:1024 lds
buffer_load_dwordx4 v4, s[12:15], s44 offen offset:2048 lds
buffer_load_dwordx4 v5, s[12:15], s44 offen offset:3072 lds
s_add_u32 m0, s53, 16384
s_add_u32 s54, s54, 1
buffer_load_dwordx4 v10, s[24:27], s45 offen offset:0 lds
buffer_load_dwordx4 v11, s[24:27], s45 offen offset:1024 lds
buffer_load_dwordx4 v12, s[24:27], s45 offen offset:2048 lds
buffer_load_dwordx4 v13, s[24:27], s45 offen offset:3072 lds
s_cmp_eq_u32 s54, 9
s_cselect_b32 s54, 0, s54
s_branch L_k1
L_k0:
s_lshl_b32 s44, s54, 7
s_add_u32 m0, s53, 0
s_add_u32 s44, s44, s50
s_lshl_b32 s45, s54, 19
s_add_u32 s45, s45, s51
buffer_load_dwordx4 v2, s[12:15], s44 offen offset:0 lds
buffer_load_dwordx4 v3, s[12:15], s44 offen offset:1024 lds
buffer_load_dwordx4 v4, s[12:15], s44 offen offset:2048 lds
buffer_load_dwordx4 v5, s[12:15], s44 offen offset:3072 lds
s_add_u32 m0, s53, 16384
s_add_u32 s54, s54, 1
buffer_load_dwordx4 v10, s[24:27], s45 offen offset:0 lds
buffer_load_dwordx4 v11, s[24:27], s45 offen offset:1024 lds
buffer_load_dwordx4 v12, s[24:27], s45 offen offset:2048 lds
buffer_load_dwordx4 v13, s[24:27], s45 offen offset:3072 lds
s_cmp_eq_u32 s54, 9
s_cselect_b32 s54, 0, s54
s_sub_u32 s10, 1, s4
s_add_u32 s11, s4, 17
s_lshl_b32 s52, s52, s11
s_lshl_b32 s18, 0x200000, s4
s_mov_b32 s19, 0x00020000
v_lshl_or_b32 v6, v28, 8, v32
v_xor_b32 v38, 64, v6
v_add_u32 v7, 1024, v38
v_add_u32 v8, 2048, v6
v_add_u32 v9, 3072, v38
L_k1:
s_lshr_b32 s7, s6, 2
s_and_b32 s8, s6, 3
s_lshl_b32 s47, s4, 2
s_add_u32 s47, s47, s5
s_cmp_eq_u32 s4, 0
s_cselect_b32 s58, 3, 3
s_and_b32 s58, s58, s5
s_add_u32 s58, s58, s8
s_and_b32 s58, s58, 3
s_lshl_b32 s48, s47, 2
s_add_u32 s48, s48, s58
s_lshl_b32 s48, s48, 18
s_add_u32 s48, s48, 4194304
s_lshl_b32 s49, s47, 19
s_add_u32 s49, s49, 12582912
s_lshl_b32 s44, s47, 2
s_lshr_b32 s45, s6, 3
s_add_u32 s45, s45, s44
s_lshl_b32 s45, s45, 7
s_add_u32 s45, s45, 2097152
s_add_u32 s44, s44, s9
s_lshl_b32 s95, s44, 16
s_lshl_b32 s96, s44, 7
s_add_u32 s96, s96, 2097152
v_mov_b32 v23, 0
v_mov_b32 v24, s96
v_writelane_b32 v24, s45, 1
s_mov_b64 exec, 3
buffer_load_dword v25, v24, s[40:43], 0 offen sc1
s_mov_b64 exec, -1
v_lshlrev_b32 v22, 4, v0
s_lshl_b32 s44, s54, 7
s_add_u32 m0, s53, 32768
s_add_u32 s44, s44, s50
s_lshl_b32 s45, s54, 19
s_add_u32 s45, s45, s51
buffer_load_dwordx4 v2, s[12:15], s44 offen offset:0 lds
buffer_load_dwordx4 v3, s[12:15], s44 offen offset:1024 lds
buffer_load_dwordx4 v4, s[12:15], s44 offen offset:2048 lds
buffer_load_dwordx4 v5, s[12:15], s44 offen offset:3072 lds
s_add_u32 m0, s53, 49152
s_add_u32 s54, s54, 1
buffer_load_dwordx4 v10, s[24:27], s45 offen offset:0 lds
buffer_load_dwordx4 v11, s[24:27], s45 offen offset:1024 lds
buffer_load_dwordx4 v12, s[24:27], s45 offen offset:2048 lds
buffer_load_dwordx4 v13, s[24:27], s45 offen offset:3072 lds
s_cmp_eq_u32 s54, 9
s_cselect_b32 s54, 0, s54
s_mov_b32 s30, 4718592
s_mov_b32 s34, 1179648
s_mov_b32 s38, 256
s_mov_b32 s22, s18
s_mov_b32 s23, 0x00020000
s_mov_b32 s31, 0x00020000
s_mov_b32 s35, 0x00020000
s_mov_b32 s39, 0x00020000
s_movk_i32 s45, 1152
v_mad_u32_u24 v14, v30, s45, v35
v_and_b32 v38, 1, v30
v_lshlrev_b32 v38, 2, v38
v_xor_b32 v38, v38, v29
v_lshlrev_b32 v38, 4, v38
v_mad_u32_u24 v18, v28, s45, v38
v_add_u32 v15, 3584, v14
v_add_u32 v19, 8192, v18
v_add_u32 v16, 7168, v14
v_add_u32 v20, 16384, v18
v_add_u32 v17, 10752, v14
v_add_u32 v21, 24576, v18
v_mov_b32 v34, 1
v_mov_b32 v24, 0x10001
v_mov_b32 v26, 0x80008000
v_and_b32 v33, 31, v0
v_lshlrev_b32 v33, 4, v33
v_lshrrev_b32 v38, 5, v0
v_lshl_or_b32 v33, v38, 14, v33
s_add_u32 s44, s53, 131072
v_add_u32 v36, s44, v22
s_lshl_b32 s44, s9, 11
s_add_u32 s44, s44, 131072
v_add_u32 v37, s44, v22
s_mul_i32 s55, s9, 18432
s_lshl_b32 s44, s58, 8
s_add_u32 s55, s55, s44
s_lshl_b32 s59, s47, 5
s_waitcnt vmcnt(8)
s_barrier
s_lshl_b32 s44, s54, 7
s_add_u32 m0, s53, 65536
s_add_u32 s44, s44, s50
s_lshl_b32 s45, s54, 19
s_add_u32 s45, s45, s51
buffer_load_dwordx4 v2, s[12:15], s44 offen offset:0 lds
buffer_load_dwordx4 v3, s[12:15], s44 offen offset:1024 lds
buffer_load_dwordx4 v4, s[12:15], s44 offen offset:2048 lds
buffer_load_dwordx4 v5, s[12:15], s44 offen offset:3072 lds
s_add_u32 m0, s53, 81920
s_add_u32 s54, s54, 1
buffer_load_dwordx4 v10, s[24:27], s45 offen offset:0 lds
buffer_load_dwordx4 v11, s[24:27], s45 offen offset:1024 lds
buffer_load_dwordx4 v12, s[24:27], s45 offen offset:2048 lds
buffer_load_dwordx4 v13, s[24:27], s45 offen offset:3072 lds
s_cmp_eq_u32 s54, 9
s_cselect_b32 s54, 0, s54
s_cmp_lg_u32 s4, 1
s_cbranch_scc1 L_k2
s_lshr_b32 s44, s6, s10
s_lshl_b32 s44, s44, 13
s_add_u32 s44, s44, s52
s_add_u32 m0, s53, 131072
s_add_u32 s45, s44, 128
buffer_load_dwordx4 v6, s[16:19], s44 offen offset:0 lds
buffer_load_dwordx4 v7, s[16:19], s44 offen offset:1024 lds
buffer_load_dwordx4 v8, s[16:19], s44 offen offset:2048 lds
buffer_load_dwordx4 v9, s[16:19], s44 offen offset:3072 lds
s_add_u32 m0, s53, 147456
s_nop 0
buffer_load_dwordx4 v6, s[16:19], s45 offen offset:0 lds
buffer_load_dwordx4 v7, s[16:19], s45 offen offset:1024 lds
buffer_load_dwordx4 v8, s[16:19], s45 offen offset:2048 lds
buffer_load_dwordx4 v9, s[16:19], s45 offen offset:3072 lds
L_k2:
v_readlane_b32 s88, v25, 0
v_readlane_b32 s89, v25, 1
v_and_b32 v120, 1, v0
v_bfe_u32 v41, v0, 2, 1
v_lshl_or_b32 v120, v41, 16, v120
v_lshrrev_b32 v41, 1, v0
v_xor_b32 v41, v41, v0
v_bfe_u32 v41, v41, 4, 1
v_bfe_u32 v121, v0, 1, 1
v_xor_b32 v121, 1, v121
v_lshl_or_b32 v121, v41, 16, v121
s_bfe_u32 s44, s88, 0x10003
s_bfe_u32 s45, s88, 0x10002
s_lshl_b32 s45, s45, 16
s_or_b32 s44, s44, s45
v_mov_b32 v122, s44
s_bfe_u32 s44, s88, 0x10001
s_and_b32 s45, s88, 1
s_lshl_b32 s45, s45, 16
s_or_b32 s44, s44, s45
v_mov_b32 v123, s44
v_lshlrev_b32 v124, 15, v120
v_lshlrev_b32 v125, 15, v121
v_lshlrev_b32 v126, 15, v122
v_lshlrev_b32 v127, 15, v123
v_and_b32 v128, 1, v0
v_bfe_u32 v41, v0, 2, 1
v_lshl_or_b32 v128, v41, 16, v128
v_lshrrev_b32 v41, 1, v0
v_xor_b32 v41, v41, v0
v_bfe_u32 v41, v41, 4, 1
v_bfe_u32 v129, v0, 1, 1
v_xor_b32 v129, 1, v129
v_lshl_or_b32 v129, v41, 16, v129
s_bfe_u32 s44, s89, 0x10003
s_bfe_u32 s45, s89, 0x10002
s_lshl_b32 s45, s45, 16
s_or_b32 s44, s44, s45
v_mov_b32 v130, s44
s_bfe_u32 s44, s89, 0x10001
s_and_b32 s45, s89, 1
s_lshl_b32 s45, s45, 16
s_or_b32 s44, s44, s45
v_mov_b32 v131, s44
s_and_b32 s44, s6, 1
s_lshl_b32 s44, s44, 2
s_add_u32 s44, s44, s9
s_lshl_b32 s44, s44, 3
v_or_b32 v40, s44, v29
v_and_b32 v132, 1, v40
v_bfe_u32 v41, v40, 2, 1
v_lshl_or_b32 v132, v41, 16, v132
v_lshrrev_b32 v41, 1, v40
v_xor_b32 v41, v41, v40
v_bfe_u32 v41, v41, 4, 1
v_bfe_u32 v133, v40, 1, 1
v_xor_b32 v133, 1, v133
v_lshl_or_b32 v133, v41, 16, v133
s_bfe_u32 s44, s89, 0x10003
s_bfe_u32 s45, s89, 0x10002
s_lshl_b32 s45, s45, 16
s_or_b32 s44, s44, s45
v_mov_b32 v134, s44
s_bfe_u32 s44, s89, 0x10001
s_and_b32 s45, s89, 1
s_lshl_b32 s45, s45, 16
s_or_b32 s44, s44, s45
v_mov_b32 v135, s44
s_waitcnt vmcnt(16)
s_cmp_eq_u32 s4, 1
s_cbranch_scc1 L_kw1
s_waitcnt vmcnt(8)
L_kw1:
s_barrier
s_lshl_b32 s44, s54, 7
s_add_u32 m0, s53, 98304
s_add_u32 s44, s44, s50
s_lshl_b32 s45, s54, 19
s_add_u32 s45, s45, s51
buffer_load_dwordx4 v2, s[12:15], s44 offen offset:0 lds
buffer_load_dwordx4 v3, s[12:15], s44 offen offset:1024 lds
buffer_load_dwordx4 v4, s[12:15], s44 offen offset:2048 lds
buffer_load_dwordx4 v5, s[12:15], s44 offen offset:3072 lds
s_add_u32 m0, s53, 114688
s_add_u32 s54, s54, 1
buffer_load_dwordx4 v10, s[24:27], s45 offen offset:0 lds
buffer_load_dwordx4 v11, s[24:27], s45 offen offset:1024 lds
buffer_load_dwordx4 v12, s[24:27], s45 offen offset:2048 lds
buffer_load_dwordx4 v13, s[24:27], s45 offen offset:3072 lds
s_cmp_eq_u32 s54, 9
s_cselect_b32 s54, 0, s54
s_waitcnt vmcnt(16)
s_cmp_eq_u32 s4, 1
s_cbranch_scc1 L_kw2
s_waitcnt vmcnt(8)
L_kw2:
s_barrier
s_lshl_b32 s44, s54, 7
s_add_u32 m0, s53, 0
s_add_u32 s44, s44, s50
s_lshl_b32 s45, s54, 19
s_add_u32 s45, s45, s51
buffer_load_dwordx4 v2, s[12:15], s44 offen offset:0 lds
buffer_load_dwordx4 v3, s[12:15], s44 offen offset:1024 lds
buffer_load_dwordx4 v4, s[12:15], s44 offen offset:2048 lds
buffer_load_dwordx4 v5, s[12:15], s44 offen offset:3072 lds
s_add_u32 m0, s53, 16384
s_add_u32 s54, s54, 1
buffer_load_dwordx4 v10, s[24:27], s45 offen offset:0 lds
buffer_load_dwordx4 v11, s[24:27], s45 offen offset:1024 lds
buffer_load_dwordx4 v12, s[24:27], s45 offen offset:2048 lds
buffer_load_dwordx4 v13, s[24:27], s45 offen offset:3072 lds
s_cmp_eq_u32 s54, 9
s_cselect_b32 s54, 0, s54
s_mov_b32 s98, 32768
s_mov_b32 s94, 4
L_lloop:
s_waitcnt vmcnt(8)
s_barrier
s_lshl_b32 s44, s54, 7
s_add_u32 m0, s53, s98
s_add_u32 s44, s44, s50
s_lshl_b32 s45, s54, 19
s_add_u32 s45, s45, s51
buffer_load_dwordx4 v2, s[12:15], s44 offen offset:0 lds
buffer_load_dwordx4 v3, s[12:15], s44 offen offset:1024 lds
buffer_load_dwordx4 v4, s[12:15], s44 offen offset:2048 lds
buffer_load_dwordx4 v5, s[12:15], s44 offen offset:3072 lds
s_add_u32 m0, m0, 16384
s_add_u32 s54, s54, 1
buffer_load_dwordx4 v10, s[24:27], s45 offen offset:0 lds
buffer_load_dwordx4 v11, s[24:27], s45 offen offset:1024 lds
buffer_load_dwordx4 v12, s[24:27], s45 offen offset:2048 lds
buffer_load_dwordx4 v13, s[24:27], s45 offen offset:3072 lds
s_cmp_eq_u32 s54, 9
s_cselect_b32 s54, 0, s54
s_add_u32 s98, s98, 0x8000
s_and_b32 s98, s98, 0x1ffff
s_sub_u32 s94, s94, 1
s_cmp_lg_u32 s94, 0
s_cbranch_scc1 L_lloop
s_waitcnt vmcnt(8)
s_barrier
s_xor_b32 s45, s6, 0
s_lshr_b32 s44, s45, s10
s_lshl_b32 s44, s44, 13
s_add_u32 s44, s44, s52
s_add_u32 m0, s53, 32768
s_mul_i32 s45, s45, 147456
s_add_u32 s45, s45, s55
buffer_load_dwordx4 v6, s[20:23], s44 offen offset:0 lds
buffer_load_dwordx4 v7, s[20:23], s44 offen offset:1024 lds
buffer_load_dwordx4 v8, s[20:23], s44 offen offset:2048 lds
buffer_load_dwordx4 v9, s[20:23], s44 offen offset:3072 lds
s_add_u32 m0, s53, 49152
s_nop 0
buffer_load_dwordx4 v14, s[28:31], s45 offen offset:0 lds
buffer_load_dwordx4 v15, s[28:31], s45 offen offset:1024 lds
buffer_load_dwordx4 v16, s[28:31], s45 offen offset:2048 lds
buffer_load_dwordx4 v17, s[28:31], s45 offen offset:3072 lds
s_waitcnt vmcnt(8)
s_barrier
s_xor_b32 s45, s6, 0
s_lshr_b32 s44, s45, s10
s_lshl_b32 s44, s44, 13
s_add_u32 s44, s44, s52
s_add_u32 s44, s44, 128
s_add_u32 m0, s53, 65536
s_mul_i32 s45, s45, 147456
s_add_u32 s45, s45, s55
buffer_load_dwordx4 v6, s[20:23], s44 offen offset:0 lds
buffer_load_dwordx4 v7, s[20:23], s44 offen offset:1024 lds
buffer_load_dwordx4 v8, s[20:23], s44 offen offset:2048 lds
buffer_load_dwordx4 v9, s[20:23], s44 offen offset:3072 lds
s_add_u32 m0, s53, 81920
s_add_u32 s45, s45, 73728
buffer_load_dwordx4 v14, s[28:31], s45 offen offset:0 lds
buffer_load_dwordx4 v15, s[28:31], s45 offen offset:1024 lds
buffer_load_dwordx4 v16, s[28:31], s45 offen offset:2048 lds
buffer_load_dwordx4 v17, s[28:31], s45 offen offset:3072 lds
s_barrier
s_lshl_b32 s44, s6, 2
s_add_u32 s44, s44, s9
s_mul_i32 s44, s44, 36864
s_add_u32 m0, s53, 98304
s_add_u32 s44, s44, 1024
buffer_load_dwordx4 v18, s[28:31], s44 offen offset:0 lds
buffer_load_dwordx4 v19, s[28:31], s44 offen offset:1024 lds
buffer_load_dwordx4 v20, s[28:31], s44 offen offset:2048 lds
buffer_load_dwordx4 v21, s[28:31], s44 offen offset:3072 lds
s_waitcnt vmcnt(12)
s_barrier
ds_read_b128 v[48:51], v36 offset:0
ds_read_b128 v[52:55], v36 offset:1024
s_lshl_b32 s44, s6, 11
s_add_u32 s44, s44, s95
s_waitcnt lgkmcnt(0)
v_bfi_b32 v48, v26, v124, v48
v_bfi_b32 v49, v26, v125, v49
v_bfi_b32 v50, v26, v126, v50
v_bfi_b32 v51, v26, v127, v51
v_bfi_b32 v52, v26, v124, v52
v_bfi_b32 v53, v26, v125, v53
v_bfi_b32 v54, v26, v126, v54
v_bfi_b32 v55, v26, v127, v55
buffer_store_dwordx4 v[48:51], v22, s[40:43], s44 offen offset:0 sc1
buffer_store_dwordx4 v[52:55], v22, s[40:43], s44 offen offset:1024 sc1
s_xor_b32 s45, s6, 1
s_lshr_b32 s44, s45, s10
s_lshl_b32 s44, s44, 13
s_add_u32 s44, s44, s52
s_add_u32 m0, s53, 0
s_mul_i32 s45, s45, 147456
s_add_u32 s45, s45, s55
buffer_load_dwordx4 v6, s[20:23], s44 offen offset:0 lds
buffer_load_dwordx4 v7, s[20:23], s44 offen offset:1024 lds
buffer_load_dwordx4 v8, s[20:23], s44 offen offset:2048 lds
buffer_load_dwordx4 v9, s[20:23], s44 offen offset:3072 lds
s_add_u32 m0, s53, 16384
s_nop 0
buffer_load_dwordx4 v14, s[28:31], s45 offen offset:0 lds
buffer_load_dwordx4 v15, s[28:31], s45 offen offset:1024 lds
buffer_load_dwordx4 v16, s[28:31], s45 offen offset:2048 lds
buffer_load_dwordx4 v17, s[28:31], s45 offen offset:3072 lds
s_waitcnt vmcnt(14)
s_barrier
s_waitcnt vmcnt(10)
s_barrier
s_xor_b32 s45, s6, 1
s_lshr_b32 s44, s45, s10
s_lshl_b32 s44, s44, 13
s_add_u32 s44, s44, s52
s_add_u32 s44, s44, 128
s_add_u32 m0, s53, 32768
s_mul_i32 s45, s45, 147456
s_add_u32 s45, s45, s55
buffer_load_dwordx4 v6, s[20:23], s44 offen offset:0 lds
buffer_load_dwordx4 v7, s[20:23], s44 offen offset:1024 lds
buffer_load_dwordx4 v8, s[20:23], s44 offen offset:2048 lds
buffer_load_dwordx4 v9, s[20:23], s44 offen offset:3072 lds
s_add_u32 m0, s53, 49152
s_add_u32 s45, s45, 73728
buffer_load_dwordx4 v14, s[28:31], s45 offen offset:0 lds
buffer_load_dwordx4 v15, s[28:31], s45 offen offset:1024 lds
buffer_load_dwordx4 v16, s[28:31], s45 offen offset:2048 lds
buffer_load_dwordx4 v17, s[28:31], s45 offen offset:3072 lds
s_cmp_lg_u32 s6, 0
s_cbranch_scc1 L_gr_n
s_mov_b64 exec, 1
buffer_load_dword v42, v23, s[36:39], s59 offen sc1
s_mov_b64 exec, -1
L_gr_n:
s_waitcnt vmcnt(8)
s_barrier
s_xor_b32 s45, s6, 2
s_lshr_b32 s44, s45, s10
s_lshl_b32 s44, s44, 13
s_add_u32 s44, s44, s52
s_add_u32 m0, s53, 65536
s_add_u32 s45, s44, 128
buffer_load_dwordx4 v6, s[20:23], s44 offen offset:0 lds
buffer_load_dwordx4 v7, s[20:23], s44 offen offset:1024 lds
buffer_load_dwordx4 v8, s[20:23], s44 offen offset:2048 lds
buffer_load_dwordx4 v9, s[20:23], s44 offen offset:3072 lds
s_add_u32 m0, s53, 81920
s_nop 0
buffer_load_dwordx4 v6, s[20:23], s45 offen offset:0 lds
buffer_load_dwordx4 v7, s[20:23], s45 offen offset:1024 lds
buffer_load_dwordx4 v8, s[20:23], s45 offen offset:2048 lds
buffer_load_dwordx4 v9, s[20:23], s45 offen offset:3072 lds
s_xor_b32 s44, s6, 1
s_lshl_b32 s44, s44, 11
s_add_u32 s44, s44, s95
buffer_load_dwordx4 v[48:51], v22, s[40:43], s44 offen offset:0 sc1
buffer_load_dwordx4 v[52:55], v22, s[40:43], s44 offen offset:1024 sc1
s_xor_b32 s44, s6, 2
s_lshl_b32 s44, s44, 11
s_add_u32 s44, s44, s95
buffer_load_dwordx4 v[56:59], v22, s[40:43], s44 offen offset:0 sc1
buffer_load_dwordx4 v[60:63], v22, s[40:43], s44 offen offset:1024 sc1
s_xor_b32 s44, s6, 3
s_lshl_b32 s44, s44, 11
s_add_u32 s44, s44, s95
buffer_load_dwordx4 v[64:67], v22, s[40:43], s44 offen offset:0 sc1
buffer_load_dwordx4 v[68:71], v22, s[40:43], s44 offen offset:1024 sc1
s_waitcnt vmcnt(14)
s_branch L_pg0
.p2align 12
L_pgpad0:
s_branch L_pgret
L_pg0:
s_barrier
ds_read_b128 v[72:75], v36 offset:0
ds_read_b128 v[76:79], v36 offset:1024
ds_read_b128 v[80:83], v36 offset:2048
ds_read_b128 v[84:87], v36 offset:3072
s_xor_b32 s45, s6, 2
s_lshl_b32 s44, s45, 2
s_add_u32 s44, s44, s9
s_mul_i32 s44, s44, 36864
s_lshl_b32 s45, s58, 8
s_add_u32 m0, s53, 98304
s_add_u32 s44, s44, s45
buffer_load_dwordx4 v18, s[28:31], s44 offen offset:0 lds
buffer_load_dwordx4 v19, s[28:31], s44 offen offset:1024 lds
buffer_load_dwordx4 v20, s[28:31], s44 offen offset:2048 lds
buffer_load_dwordx4 v21, s[28:31], s44 offen offset:3072 lds
s_xor_b32 s45, s6, 3
s_lshl_b32 s44, s45, 2
s_add_u32 s44, s44, s9
s_mul_i32 s44, s44, 36864
s_lshl_b32 s45, s58, 8
s_add_u32 m0, s53, 114688
s_add_u32 s44, s44, s45
buffer_load_dwordx4 v18, s[28:31], s44 offen offset:0 lds
buffer_load_dwordx4 v19, s[28:31], s44 offen offset:1024 lds
buffer_load_dwordx4 v20, s[28:31], s44 offen offset:2048 lds
buffer_load_dwordx4 v21, s[28:31], s44 offen offset:3072 lds
s_waitcnt lgkmcnt(0)
v_bfi_b32 v72, v24, v120, v72
v_bfi_b32 v73, v24, v121, v73
v_bfi_b32 v74, v24, v122, v74
v_bfi_b32 v75, v24, v123, v75
v_bfi_b32 v76, v24, v120, v76
v_bfi_b32 v77, v24, v121, v77
v_bfi_b32 v78, v24, v122, v78
v_bfi_b32 v79, v24, v123, v79
v_bfi_b32 v80, v24, v120, v80
v_bfi_b32 v81, v24, v121, v81
v_bfi_b32 v82, v24, v122, v82
v_bfi_b32 v83, v24, v123, v83
v_bfi_b32 v84, v24, v120, v84
v_bfi_b32 v85, v24, v121, v85
v_bfi_b32 v86, v24, v122, v86
v_bfi_b32 v87, v24, v123, v87
s_lshl_b32 s44, s9, 17
s_add_u32 s45, s49, s44
s_lshl_b32 s44, s6, 9
s_add_u32 s45, s45, s44
s_add_u32 s44, s45, 0
buffer_store_dwordx4 v[72:75], v33, s[40:43], s44 offen sc1
s_add_u32 s44, s45, 32768
buffer_store_dwordx4 v[76:79], v33, s[40:43], s44 offen sc1
s_add_u32 s44, s45, 65536
buffer_store_dwordx4 v[80:83], v33, s[40:43], s44 offen sc1
s_add_u32 s44, s45, 98304
buffer_store_dwordx4 v[84:87], v33, s[40:43], s44 offen sc1
s_barrier
s_waitcnt vmcnt(12)
s_mov_b32 s93, 7
s_bitcmp1_b32 s93, 0
s_cbranch_scc0 L_pa_n1
v_xor_b32 v144, v124, v48
v_xor_b32 v145, v125, v49
v_xor_b32 v146, v126, v50
v_xor_b32 v147, v127, v51
v_xor_b32 v148, v124, v52
v_xor_b32 v149, v125, v53
v_xor_b32 v150, v126, v54
v_xor_b32 v151, v127, v55
v_or3_b32 v27, v144, v145, v146
v_or3_b32 v27, v27, v147, v148
v_or3_b32 v27, v27, v149, v150
v_or_b32 v27, v27, v151
v_and_b32 v27, v27, v26
v_cmp_ne_u32 vcc, 0, v27
s_cbranch_vccnz L_pa_r1
s_bitset0_b32 s93, 0
ds_write_b128 v37, v[144:147] offset:16384
ds_write_b128 v37, v[148:151] offset:17408
s_branch L_pa_n1
L_pa_r1:
s_xor_b32 s44, s6, 1
s_lshl_b32 s44, s44, 11
s_add_u32 s44, s44, s95
buffer_load_dwordx4 v[48:51], v22, s[40:43], s44 offen offset:0 sc1
buffer_load_dwordx4 v[52:55], v22, s[40:43], s44 offen offset:1024 sc1
L_pa_n1:
s_bitcmp1_b32 s93, 1
s_cbranch_scc0 L_pa_n2
v_xor_b32 v152, v124, v56
v_xor_b32 v153, v125, v57
v_xor_b32 v154, v126, v58
v_xor_b32 v155, v127, v59
v_xor_b32 v156, v124, v60
v_xor_b32 v157, v125, v61
v_xor_b32 v158, v126, v62
v_xor_b32 v159, v127, v63
v_or3_b32 v27, v152, v153, v154
v_or3_b32 v27, v27, v155, v156
v_or3_b32 v27, v27, v157, v158
v_or_b32 v27, v27, v159
v_and_b32 v27, v27, v26
v_cmp_ne_u32 vcc, 0, v27
s_cbranch_vccnz L_pa_r2
s_bitset0_b32 s93, 1
ds_write_b128 v37, v[152:155] offset:24576
ds_write_b128 v37, v[156:159] offset:25600
s_branch L_pa_n2
L_pa_r2:
s_xor_b32 s44, s6, 2
s_lshl_b32 s44, s44, 11
s_add_u32 s44, s44, s95
buffer_load_dwordx4 v[56:59], v22, s[40:43], s44 offen offset:0 sc1
buffer_load_dwordx4 v[60:63], v22, s[40:43], s44 offen offset:1024 sc1
L_pa_n2:
s_bitcmp1_b32 s93, 2
s_cbranch_scc0 L_pa_n3
v_xor_b32 v160, v124, v64
v_xor_b32 v161, v125, v65
v_xor_b32 v162, v126, v66
v_xor_b32 v163, v127, v67
v_xor_b32 v164, v124, v68
v_xor_b32 v165, v125, v69
v_xor_b32 v166, v126, v70
v_xor_b32 v167, v127, v71
v_or3_b32 v27, v160, v161, v162
v_or3_b32 v27, v27, v163, v164
v_or3_b32 v27, v27, v165, v166
v_or_b32 v27, v27, v167
v_and_b32 v27, v27, v26
v_cmp_ne_u32 vcc, 0, v27
s_cbranch_vccnz L_pa_r3
s_bitset0_b32 s93, 2
ds_write_b128 v37, v[160:163] offset:0
ds_write_b128 v37, v[164:167] offset:1024
s_branch L_pa_n3
L_pa_r3:
s_xor_b32 s44, s6, 3
s_lshl_b32 s44, s44, 11
s_add_u32 s44, s44, s95
buffer_load_dwordx4 v[64:67], v22, s[40:43], s44 offen offset:0 sc1
buffer_load_dwordx4 v[68:71], v22, s[40:43], s44 offen offset:1024 sc1
L_pa_n3:
v_mov_b32 v41, s88
ds_write_b32 v37, v41 offset:8192
s_waitcnt vmcnt(4)
s_barrier
s_cmp_eq_u32 s4, 0
s_cbranch_scc1 L_no17
s_xor_b32 s45, s6, 3
s_lshr_b32 s44, s45, s10
s_lshl_b32 s44, s44, 13
s_add_u32 s44, s44, s52
s_add_u32 m0, s53, 0
s_add_u32 s45, s44, 128
buffer_load_dwordx4 v6, s[20:23], s44 offen offset:0 lds
buffer_load_dwordx4 v7, s[20:23], s44 offen offset:1024 lds
buffer_load_dwordx4 v8, s[20:23], s44 offen offset:2048 lds
buffer_load_dwordx4 v9, s[20:23], s44 offen offset:3072 lds
s_add_u32 m0, s53, 16384
s_nop 0
buffer_load_dwordx4 v6, s[20:23], s45 offen offset:0 lds
buffer_load_dwordx4 v7, s[20:23], s45 offen offset:1024 lds
buffer_load_dwordx4 v8, s[20:23], s45 offen offset:2048 lds
buffer_load_dwordx4 v9, s[20:23], s45 offen offset:3072 lds
L_no17:
s_xor_b32 s45, s6, 2
s_lshl_b32 s44, s45, 2
s_add_u32 s44, s44, s9
s_mul_i32 s44, s44, 36864
s_lshl_b32 s45, s58, 8
s_add_u32 m0, s53, 32768
s_add_u32 s44, s44, s45
s_add_u32 s44, s44, 128
buffer_load_dwordx4 v18, s[28:31], s44 offen offset:0 lds
buffer_load_dwordx4 v19, s[28:31], s44 offen offset:1024 lds
buffer_load_dwordx4 v20, s[28:31], s44 offen offset:2048 lds
buffer_load_dwordx4 v21, s[28:31], s44 offen offset:3072 lds
s_xor_b32 s45, s6, 3
s_lshl_b32 s44, s45, 2
s_add_u32 s44, s44, s9
s_mul_i32 s44, s44, 36864
s_lshl_b32 s45, s58, 8
s_add_u32 m0, s53, 49152
s_add_u32 s44, s44, s45
s_add_u32 s44, s44, 128
buffer_load_dwordx4 v18, s[28:31], s44 offen offset:0 lds
buffer_load_dwordx4 v19, s[28:31], s44 offen offset:1024 lds
buffer_load_dwordx4 v20, s[28:31], s44 offen offset:2048 lds
buffer_load_dwordx4 v21, s[28:31], s44 offen offset:3072 lds
s_mov_b32 s94, 0
s_cmp_eq_u32 s93, 0
s_cbranch_scc1 L_pok
s_waitcnt vmcnt(8)
L_pb:
s_bitcmp1_b32 s93, 0
s_cbranch_scc0 L_pb_n1
v_xor_b32 v144, v124, v48
v_xor_b32 v145, v125, v49
v_xor_b32 v146, v126, v50
v_xor_b32 v147, v127, v51
v_xor_b32 v148, v124, v52
v_xor_b32 v149, v125, v53
v_xor_b32 v150, v126, v54
v_xor_b32 v151, v127, v55
v_or3_b32 v27, v144, v145, v146
v_or3_b32 v27, v27, v147, v148
v_or3_b32 v27, v27, v149, v150
v_or_b32 v27, v27, v151
v_and_b32 v27, v27, v26
v_cmp_ne_u32 vcc, 0, v27
s_cbranch_vccnz L_pb_r1
s_bitset0_b32 s93, 0
ds_write_b128 v37, v[144:147] offset:16384
ds_write_b128 v37, v[148:151] offset:17408
s_branch L_pb_n1
L_pb_r1:
s_xor_b32 s44, s6, 1
s_lshl_b32 s44, s44, 11
s_add_u32 s44, s44, s95
buffer_load_dwordx4 v[48:51], v22, s[40:43], s44 offen offset:0 sc1
buffer_load_dwordx4 v[52:55], v22, s[40:43], s44 offen offset:1024 sc1
L_pb_n1:
s_bitcmp1_b32 s93, 1
s_cbranch_scc0 L_pb_n2
v_xor_b32 v152, v124, v56
v_xor_b32 v153, v125, v57
v_xor_b32 v154, v126, v58
v_xor_b32 v155, v127, v59
v_xor_b32 v156, v124, v60
v_xor_b32 v157, v125, v61
v_xor_b32 v158, v126, v62
v_xor_b32 v159, v127, v63
v_or3_b32 v27, v152, v153, v154
v_or3_b32 v27, v27, v155, v156
v_or3_b32 v27, v27, v157, v158
v_or_b32 v27, v27, v159
v_and_b32 v27, v27, v26
v_cmp_ne_u32 vcc, 0, v27
s_cbranch_vccnz L_pb_r2
s_bitset0_b32 s93, 1
ds_write_b128 v37, v[152:155] offset:24576
ds_write_b128 v37, v[156:159] offset:25600
s_branch L_pb_n2
L_pb_r2:
s_xor_b32 s44, s6, 2
s_lshl_b32 s44, s44, 11
s_add_u32 s44, s44, s95
buffer_load_dwordx4 v[56:59], v22, s[40:43], s44 offen offset:0 sc1
buffer_load_dwordx4 v[60:63], v22, s[40:43], s44 offen offset:1024 sc1
L_pb_n2:
s_bitcmp1_b32 s93, 2
s_cbranch_scc0 L_pb_n3
v_xor_b32 v160, v124, v64
v_xor_b32 v161, v125, v65
v_xor_b32 v162, v126, v66
v_xor_b32 v163, v127, v67
v_xor_b32 v164, v124, v68
v_xor_b32 v165, v125, v69
v_xor_b32 v166, v126, v70
v_xor_b32 v167, v127, v71
v_or3_b32 v27, v160, v161, v162
v_or3_b32 v27, v27, v163, v164
v_or3_b32 v27, v27, v165, v166
v_or_b32 v27, v27, v167
v_and_b32 v27, v27, v26
v_cmp_ne_u32 vcc, 0, v27
s_cbranch_vccnz L_pb_r3
s_bitset0_b32 s93, 2
ds_write_b128 v37, v[160:163] offset:0
ds_write_b128 v37, v[164:167] offset:1024
s_branch L_pb_n3
L_pb_r3:
s_xor_b32 s44, s6, 3
s_lshl_b32 s44, s44, 11
s_add_u32 s44, s44, s95
buffer_load_dwordx4 v[64:67], v22, s[40:43], s44 offen offset:0 sc1
buffer_load_dwordx4 v[68:71], v22, s[40:43], s44 offen offset:1024 sc1
L_pb_n3:
s_cmp_eq_u32 s93, 0
s_cbranch_scc1 L_pok
s_waitcnt vmcnt(0)
s_add_u32 s94, s94, 1
s_cmp_lt_u32 s94, 2097152
s_cbranch_scc1 L_pb
L_pok:
s_waitcnt lgkmcnt(0)
s_cmp_lg_u32 s6, 0
s_cbranch_scc1 L_gr_done
s_mov_b64 exec, 1
s_mov_b32 s94, 0
L_gr:
v_cmp_gt_u32 vcc, 32, v42
s_cbranch_vccz L_gr_go
s_add_u32 s94, s94, 1
s_cmp_ge_u32 s94, 2097152
s_cbranch_scc1 L_gr_go
s_sleep 2
buffer_load_dword v42, v23, s[36:39], s59 offen sc1
s_waitcnt vmcnt(0)
s_branch L_gr
L_gr_go:
buffer_atomic_add v34, v23, s[40:43], s96 offen sc1
s_mov_b64 exec, -1
L_gr_done:
s_waitcnt vmcnt(8)
s_barrier
v_lshlrev_b32 v43, 9, v28
v_lshl_or_b32 v43, v29, 4, v43
s_lshl_b32 s44, s6, 14
s_add_u32 s49, s49, s44
s_lshl_b32 s44, s9, 7
s_add_u32 s49, s49, s44
s_add_u32 s44, s49, 0
buffer_load_dwordx4 v[104:107], v43, s[40:43], s44 offen sc1
s_add_u32 s44, s49, 4096
buffer_load_dwordx4 v[108:111], v43, s[40:43], s44 offen sc1
s_add_u32 s44, s49, 8192
buffer_load_dwordx4 v[112:115], v43, s[40:43], s44 offen sc1
s_add_u32 s44, s49, 12288
buffer_load_dwordx4 v[116:119], v43, s[40:43], s44 offen sc1
s_waitcnt vmcnt(4)
s_barrier
s_mov_b32 s50, 0x3f80
s_mov_b32 s51, 0x3f800000
s_movk_i32 s45, 2304
v_mul_u32_u24 v44, s45, v0
v_and_b32 v45, 31, v0
v_mul_u32_u24 v45, s45, v45
v_lshrrev_b32 v46, 5, v0
v_lshl_add_u32 v45, v46, 4, v45
s_lshl_b32 s44, s7, 15
s_add_u32 s48, s48, s44
s_lshl_b32 s44, s9, 13
s_add_u32 s48, s48, s44
s_lshl_b32 s44, s5, 2
s_lshr_b32 s45, s7, 1
s_add_u32 s44, s44, s45
s_mul_i32 s55, s44, 73728
s_mul_i32 s52, s4, 1152
s_add_u32 s55, s55, s52
s_lshl_b32 s45, s58, 8
s_add_u32 s55, s55, s45
s_and_b32 s45, s7, 1
s_lshl_b32 s45, s45, 6
s_add_u32 s55, s55, s45
s_lshr_b32 s45, s9, 1
s_lshl_b32 s45, s45, 7
s_add_u32 s55, s55, s45
s_and_b32 s45, s9, 1
s_lshl_b32 s45, s45, 5
s_add_u32 s55, s55, s45
s_lshl_b32 s44, s5, 2
s_lshr_b32 s45, s6, 3
s_add_u32 s44, s44, s45
s_lshl_b32 s44, s44, 2
s_add_u32 s44, s44, s9
s_mul_i32 s44, s44, 18432
s_add_u32 s52, s52, s44
s_and_b32 s45, s6, 7
s_lshl_b32 s45, s45, 4
s_add_u32 s52, s52, s45
v_mov_b32 v48, 0
v_mov_b32 v49, 0
v_mov_b32 v50, 0
v_mov_b32 v51, 0
v_mov_b32 v47, 98304
ds_write_b128 v47, v[48:51] offset:0
s_waitcnt lgkmcnt(0)
s_barrier
s_mov_b32 s94, 0
s_mov_b32 s93, 15
s_branch L_r9_w
L_r9:
s_bitcmp1_b32 s93, 0
s_cbranch_scc0 L_r9_s0
s_add_u32 s44, s49, 0
buffer_load_dwordx4 v[104:107], v43, s[40:43], s44 offen offset:0 sc1
L_r9_s0:
s_bitcmp1_b32 s93, 1
s_cbranch_scc0 L_r9_s1
s_add_u32 s44, s49, 4096
buffer_load_dwordx4 v[108:111], v43, s[40:43], s44 offen offset:0 sc1
L_r9_s1:
s_bitcmp1_b32 s93, 2
s_cbranch_scc0 L_r9_s2
s_add_u32 s44, s49, 8192
buffer_load_dwordx4 v[112:115], v43, s[40:43], s44 offen offset:0 sc1
L_r9_s2:
s_bitcmp1_b32 s93, 3
s_cbranch_scc0 L_r9_s3
s_add_u32 s44, s49, 12288
buffer_load_dwordx4 v[116:119], v43, s[40:43], s44 offen offset:0 sc1
L_r9_s3:
L_r9_w:
s_waitcnt vmcnt(0)
s_bitcmp1_b32 s93, 0
s_cbranch_scc0 L_r9_c0
v_xor_b32 v104, v132, v104
v_xor_b32 v105, v133, v105
v_xor_b32 v106, v134, v106
v_xor_b32 v107, v135, v107
v_or3_b32 v27, v104, v105, v106
v_or_b32 v27, v27, v107
v_and_b32 v27, v27, v24
v_cmp_ne_u32 vcc, 0, v27
s_cbranch_vccnz L_r9_c0
s_bitset0_b32 s93, 0
L_r9_c0:
s_bitcmp1_b32 s93, 1
s_cbranch_scc0 L_r9_c1
v_xor_b32 v108, v132, v108
v_xor_b32 v109, v133, v109
v_xor_b32 v110, v134, v110
v_xor_b32 v111, v135, v111
v_or3_b32 v27, v108, v109, v110
v_or_b32 v27, v27, v111
v_and_b32 v27, v27, v24
v_cmp_ne_u32 vcc, 0, v27
s_cbranch_vccnz L_r9_c1
s_bitset0_b32 s93, 1
L_r9_c1:
s_bitcmp1_b32 s93, 2
s_cbranch_scc0 L_r9_c2
v_xor_b32 v112, v132, v112
v_xor_b32 v113, v133, v113
v_xor_b32 v114, v134, v114
v_xor_b32 v115, v135, v115
v_or3_b32 v27, v112, v113, v114
v_or_b32 v27, v27, v115
v_and_b32 v27, v27, v24
v_cmp_ne_u32 vcc, 0, v27
s_cbranch_vccnz L_r9_c2
s_bitset0_b32 s93, 2
L_r9_c2:
s_bitcmp1_b32 s93, 3
s_cbranch_scc0 L_r9_c3
v_xor_b32 v116, v132, v116
v_xor_b32 v117, v133, v117
v_xor_b32 v118, v134, v118
v_xor_b32 v119, v135, v119
v_or3_b32 v27, v116, v117, v118
v_or_b32 v27, v27, v119
v_and_b32 v27, v27, v24
v_cmp_ne_u32 vcc, 0, v27
s_cbranch_vccnz L_r9_c3
s_bitset0_b32 s93, 3
L_r9_c3:
s_cmp_eq_u32 s93, 0
s_cbranch_scc1 L_r9_ok
s_add_u32 s94, s94, 1
s_cmp_lt_u32 s94, 2097152
s_cbranch_scc1 L_r9
L_r9_ok:
v_mov_b32 v96, 0
v_mov_b32 v97, 0
v_mov_b32 v98, 0
v_mov_b32 v99, 0
v_mov_b32 v100, 0
v_mov_b32 v101, 0
v_mov_b32 v102, 0
v_mov_b32 v103, 0
v_dot2c_f32_bf16 v96, s50, v104
v_dot2c_f32_bf16 v97, s51, v104
v_dot2c_f32_bf16 v98, s50, v105
v_dot2c_f32_bf16 v99, s51, v105
v_dot2c_f32_bf16 v100, s50, v106
v_dot2c_f32_bf16 v101, s51, v106
v_dot2c_f32_bf16 v102, s50, v107
v_dot2c_f32_bf16 v103, s51, v107
v_dot2c_f32_bf16 v96, s50, v108
v_dot2c_f32_bf16 v97, s51, v108
v_dot2c_f32_bf16 v98, s50, v109
v_dot2c_f32_bf16 v99, s51, v109
v_dot2c_f32_bf16 v100, s50, v110
v_dot2c_f32_bf16 v101, s51, v110
v_dot2c_f32_bf16 v102, s50, v111
v_dot2c_f32_bf16 v103, s51, v111
v_dot2c_f32_bf16 v96, s50, v112
v_dot2c_f32_bf16 v97, s51, v112
v_dot2c_f32_bf16 v98, s50, v113
v_dot2c_f32_bf16 v99, s51, v113
v_dot2c_f32_bf16 v100, s50, v114
v_dot2c_f32_bf16 v101, s51, v114
v_dot2c_f32_bf16 v102, s50, v115
v_dot2c_f32_bf16 v103, s51, v115
v_dot2c_f32_bf16 v96, s50, v116
v_dot2c_f32_bf16 v97, s51, v116
v_dot2c_f32_bf16 v98, s50, v117
v_dot2c_f32_bf16 v99, s51, v117
v_dot2c_f32_bf16 v100, s50, v118
v_dot2c_f32_bf16 v101, s51, v118
v_dot2c_f32_bf16 v102, s50, v119
v_dot2c_f32_bf16 v103, s51, v119
v_add_f32_dpp v96, v96, v96 row_ror:8 row_mask:0xf bank_mask:0xf
v_add_f32_dpp v97, v97, v97 row_ror:8 row_mask:0xf bank_mask:0xf
v_add_f32_dpp v98, v98, v98 row_ror:8 row_mask:0xf bank_mask:0xf
v_add_f32_dpp v99, v99, v99 row_ror:8 row_mask:0xf bank_mask:0xf
v_add_f32_dpp v100, v100, v100 row_ror:8 row_mask:0xf bank_mask:0xf
v_add_f32_dpp v101, v101, v101 row_ror:8 row_mask:0xf bank_mask:0xf
v_add_f32_dpp v102, v102, v102 row_ror:8 row_mask:0xf bank_mask:0xf
v_add_f32_dpp v103, v103, v103 row_ror:8 row_mask:0xf bank_mask:0xf
v_mov_b32 v52, v96
v_mov_b32 v53, v97
v_mov_b32 v54, v98
v_mov_b32 v55, v99
v_mov_b32 v56, v100
v_mov_b32 v57, v101
v_mov_b32 v58, v102
v_mov_b32 v59, v103
v_permlane16_swap_b32 v96, v52
v_permlane16_swap_b32 v97, v53
v_permlane16_swap_b32 v98, v54
v_permlane16_swap_b32 v99, v55
v_permlane16_swap_b32 v100, v56
v_permlane16_swap_b32 v101, v57
v_permlane16_swap_b32 v102, v58
v_permlane16_swap_b32 v103, v59
v_add_f32 v96, v96, v52
v_add_f32 v97, v97, v53
v_add_f32 v98, v98, v54
v_add_f32 v99, v99, v55
v_add_f32 v100, v100, v56
v_add_f32 v101, v101, v57
v_add_f32 v102, v102, v58
v_add_f32 v103, v103, v59
v_mov_b32 v52, v96
v_mov_b32 v53, v97
v_mov_b32 v54, v98
v_mov_b32 v55, v99
v_mov_b32 v56, v100
v_mov_b32 v57, v101
v_mov_b32 v58, v102
v_mov_b32 v59, v103
v_permlane32_swap_b32 v96, v52
v_permlane32_swap_b32 v97, v53
v_permlane32_swap_b32 v98, v54
v_permlane32_swap_b32 v99, v55
v_permlane32_swap_b32 v100, v56
v_permlane32_swap_b32 v101, v57
v_permlane32_swap_b32 v102, v58
v_permlane32_swap_b32 v103, v59
v_add_f32 v96, v96, v52
v_add_f32 v97, v97, v53
v_add_f32 v98, v98, v54
v_add_f32 v99, v99, v55
v_add_f32 v100, v100, v56
v_add_f32 v101, v101, v57
v_add_f32 v102, v102, v58
v_add_f32 v103, v103, v59
v_cvt_pk_bf16_f32 v60, v96, v97
v_cvt_pk_bf16_f32 v61, v98, v99
v_cvt_pk_bf16_f32 v62, v100, v101
v_cvt_pk_bf16_f32 v63, v102, v103
s_mov_b64 exec, 0xff
buffer_store_dwordx4 v[60:63], v44, s[32:35], s52 offen offset:1024
s_mov_b64 exec, -1
L_no9:
s_cmp_lt_u32 s9, 2
s_cselect_b32 s45, 1, 2
v_mov_b32 v64, 0
v_mov_b32 v65, 0
v_mov_b32 v66, 0
v_mov_b32 v67, 0
v_mov_b32 v68, 0
v_mov_b32 v69, 0
v_mov_b32 v70, 0
v_mov_b32 v71, 0
v_mov_b32 v72, 0
v_mov_b32 v73, 0
v_mov_b32 v74, 0
v_mov_b32 v75, 0
v_mov_b32 v76, 0
v_mov_b32 v77, 0
v_mov_b32 v78, 0
v_mov_b32 v79, 0
v_mov_b32 v80, 0
v_mov_b32 v81, 0
v_mov_b32 v82, 0
v_mov_b32 v83, 0
v_mov_b32 v84, 0
v_mov_b32 v85, 0
v_mov_b32 v86, 0
v_mov_b32 v87, 0
v_mov_b32 v88, 0
v_mov_b32 v89, 0
v_mov_b32 v90, 0
v_mov_b32 v91, 0
v_mov_b32 v92, 0
v_mov_b32 v93, 0
v_mov_b32 v94, 0
v_mov_b32 v95, 0
s_mov_b32 s94, 0
L_wB:
s_sleep 1
ds_read_b128 v[48:51], v47 offset:0
s_waitcnt lgkmcnt(0)
v_min3_u32 v46, v48, v49, v50
v_min_u32 v46, v46, v51
v_cmp_gt_u32 vcc, s45, v46
s_cbranch_vccz L_goA
s_add_u32 s94, s94, 1
s_cmp_lt_u32 s94, 16777216
s_cbranch_scc1 L_wB
L_goA:
s_lshl_b32 s44, s9, 10
s_add_u32 s44, s44, 98304
v_add_u32 v46, s44, v22
s_mov_b32 s94, 0
s_mov_b32 s93, 255
s_bitset0_b32 s93, s7
ds_read_b128 v[52:55], v46 offset:4096
L_rm:
s_bitcmp1_b32 s93, 0
s_cbranch_scc0 L_rm_s0
s_add_u32 s44, s48, 0
buffer_load_dwordx4 v[64:67], v22, s[40:43], s44 offen offset:0 sc1
L_rm_s0:
s_bitcmp1_b32 s93, 1
s_cbranch_scc0 L_rm_s1
s_add_u32 s44, s48, 0
buffer_load_dwordx4 v[68:71], v22, s[40:43], s44 offen offset:1024 sc1
L_rm_s1:
s_bitcmp1_b32 s93, 2
s_cbranch_scc0 L_rm_s2
s_add_u32 s44, s48, 0
buffer_load_dwordx4 v[72:75], v22, s[40:43], s44 offen offset:2048 sc1
L_rm_s2:
s_bitcmp1_b32 s93, 3
s_cbranch_scc0 L_rm_s3
s_add_u32 s44, s48, 0
buffer_load_dwordx4 v[76:79], v22, s[40:43], s44 offen offset:3072 sc1
L_rm_s3:
s_bitcmp1_b32 s93, 4
s_cbranch_scc0 L_rm_s4
s_add_u32 s44, s48, 4096
buffer_load_dwordx4 v[80:83], v22, s[40:43], s44 offen offset:0 sc1
L_rm_s4:
s_bitcmp1_b32 s93, 5
s_cbranch_scc0 L_rm_s5
s_add_u32 s44, s48, 4096
buffer_load_dwordx4 v[84:87], v22, s[40:43], s44 offen offset:1024 sc1
L_rm_s5:
s_bitcmp1_b32 s93, 6
s_cbranch_scc0 L_rm_s6
s_add_u32 s44, s48, 4096
buffer_load_dwordx4 v[88:91], v22, s[40:43], s44 offen offset:2048 sc1
L_rm_s6:
s_bitcmp1_b32 s93, 7
s_cbranch_scc0 L_rm_s7
s_add_u32 s44, s48, 4096
buffer_load_dwordx4 v[92:95], v22, s[40:43], s44 offen offset:3072 sc1
L_rm_s7:
L_rm_w:
s_waitcnt vmcnt(0)
s_bitcmp1_b32 s93, 0
s_cbranch_scc0 L_rm_c0
v_xor_b32 v64, v128, v64
v_xor_b32 v65, v129, v65
v_xor_b32 v66, v130, v66
v_xor_b32 v67, v131, v67
v_or3_b32 v27, v64, v65, v66
v_or_b32 v27, v27, v67
v_and_b32 v27, v27, v24
v_cmp_ne_u32 vcc, 0, v27
s_cbranch_vccnz L_rm_c0
s_bitset0_b32 s93, 0
L_rm_c0:
s_bitcmp1_b32 s93, 1
s_cbranch_scc0 L_rm_c1
v_xor_b32 v68, v128, v68
v_xor_b32 v69, v129, v69
v_xor_b32 v70, v130, v70
v_xor_b32 v71, v131, v71
v_or3_b32 v27, v68, v69, v70
v_or_b32 v27, v27, v71
v_and_b32 v27, v27, v24
v_cmp_ne_u32 vcc, 0, v27
s_cbranch_vccnz L_rm_c1
s_bitset0_b32 s93, 1
L_rm_c1:
s_bitcmp1_b32 s93, 2
s_cbranch_scc0 L_rm_c2
v_xor_b32 v72, v128, v72
v_xor_b32 v73, v129, v73
v_xor_b32 v74, v130, v74
v_xor_b32 v75, v131, v75
v_or3_b32 v27, v72, v73, v74
v_or_b32 v27, v27, v75
v_and_b32 v27, v27, v24
v_cmp_ne_u32 vcc, 0, v27
s_cbranch_vccnz L_rm_c2
s_bitset0_b32 s93, 2
L_rm_c2:
s_bitcmp1_b32 s93, 3
s_cbranch_scc0 L_rm_c3
v_xor_b32 v76, v128, v76
v_xor_b32 v77, v129, v77
v_xor_b32 v78, v130, v78
v_xor_b32 v79, v131, v79
v_or3_b32 v27, v76, v77, v78
v_or_b32 v27, v27, v79
v_and_b32 v27, v27, v24
v_cmp_ne_u32 vcc, 0, v27
s_cbranch_vccnz L_rm_c3
s_bitset0_b32 s93, 3
L_rm_c3:
s_bitcmp1_b32 s93, 4
s_cbranch_scc0 L_rm_c4
v_xor_b32 v80, v128, v80
v_xor_b32 v81, v129, v81
v_xor_b32 v82, v130, v82
v_xor_b32 v83, v131, v83
v_or3_b32 v27, v80, v81, v82
v_or_b32 v27, v27, v83
v_and_b32 v27, v27, v24
v_cmp_ne_u32 vcc, 0, v27
s_cbranch_vccnz L_rm_c4
s_bitset0_b32 s93, 4
L_rm_c4:
s_bitcmp1_b32 s93, 5
s_cbranch_scc0 L_rm_c5
v_xor_b32 v84, v128, v84
v_xor_b32 v85, v129, v85
v_xor_b32 v86, v130, v86
v_xor_b32 v87, v131, v87
v_or3_b32 v27, v84, v85, v86
v_or_b32 v27, v27, v87
v_and_b32 v27, v27, v24
v_cmp_ne_u32 vcc, 0, v27
s_cbranch_vccnz L_rm_c5
s_bitset0_b32 s93, 5
L_rm_c5:
s_bitcmp1_b32 s93, 6
s_cbranch_scc0 L_rm_c6
v_xor_b32 v88, v128, v88
v_xor_b32 v89, v129, v89
v_xor_b32 v90, v130, v90
v_xor_b32 v91, v131, v91
v_or3_b32 v27, v88, v89, v90
v_or_b32 v27, v27, v91
v_and_b32 v27, v27, v24
v_cmp_ne_u32 vcc, 0, v27
s_cbranch_vccnz L_rm_c6
s_bitset0_b32 s93, 6
L_rm_c6:
s_bitcmp1_b32 s93, 7
s_cbranch_scc0 L_rm_c7
v_xor_b32 v92, v128, v92
v_xor_b32 v93, v129, v93
v_xor_b32 v94, v130, v94
v_xor_b32 v95, v131, v95
v_or3_b32 v27, v92, v93, v94
v_or_b32 v27, v27, v95
v_and_b32 v27, v27, v24
v_cmp_ne_u32 vcc, 0, v27
s_cbranch_vccnz L_rm_c7
s_bitset0_b32 s93, 7
L_rm_c7:
s_cmp_eq_u32 s93, 0
s_cbranch_scc1 L_rm_ok
s_add_u32 s94, s94, 1
s_cmp_lt_u32 s94, 2097152
s_cbranch_scc1 L_rm
L_rm_ok:
v_mov_b32 v96, 0
v_mov_b32 v97, 0
v_mov_b32 v98, 0
v_mov_b32 v99, 0
v_mov_b32 v100, 0
v_mov_b32 v101, 0
v_mov_b32 v102, 0
v_mov_b32 v103, 0
s_waitcnt lgkmcnt(0)
v_xor_b32 v52, v128, v52
v_xor_b32 v53, v129, v53
v_xor_b32 v54, v130, v54
v_xor_b32 v55, v131, v55
v_dot2c_f32_bf16 v96, s50, v64
v_dot2c_f32_bf16 v97, s51, v64
v_dot2c_f32_bf16 v98, s50, v65
v_dot2c_f32_bf16 v99, s51, v65
v_dot2c_f32_bf16 v100, s50, v66
v_dot2c_f32_bf16 v101, s51, v66
v_dot2c_f32_bf16 v102, s50, v67
v_dot2c_f32_bf16 v103, s51, v67
v_dot2c_f32_bf16 v96, s50, v68
v_dot2c_f32_bf16 v97, s51, v68
v_dot2c_f32_bf16 v98, s50, v69
v_dot2c_f32_bf16 v99, s51, v69
v_dot2c_f32_bf16 v100, s50, v70
v_dot2c_f32_bf16 v101, s51, v70
v_dot2c_f32_bf16 v102, s50, v71
v_dot2c_f32_bf16 v103, s51, v71
v_dot2c_f32_bf16 v96, s50, v72
v_dot2c_f32_bf16 v97, s51, v72
v_dot2c_f32_bf16 v98, s50, v73
v_dot2c_f32_bf16 v99, s51, v73
v_dot2c_f32_bf16 v100, s50, v74
v_dot2c_f32_bf16 v101, s51, v74
v_dot2c_f32_bf16 v102, s50, v75
v_dot2c_f32_bf16 v103, s51, v75
v_dot2c_f32_bf16 v96, s50, v76
v_dot2c_f32_bf16 v97, s51, v76
v_dot2c_f32_bf16 v98, s50, v77
v_dot2c_f32_bf16 v99, s51, v77
v_dot2c_f32_bf16 v100, s50, v78
v_dot2c_f32_bf16 v101, s51, v78
v_dot2c_f32_bf16 v102, s50, v79
v_dot2c_f32_bf16 v103, s51, v79
v_dot2c_f32_bf16 v96, s50, v80
v_dot2c_f32_bf16 v97, s51, v80
v_dot2c_f32_bf16 v98, s50, v81
v_dot2c_f32_bf16 v99, s51, v81
v_dot2c_f32_bf16 v100, s50, v82
v_dot2c_f32_bf16 v101, s51, v82
v_dot2c_f32_bf16 v102, s50, v83
v_dot2c_f32_bf16 v103, s51, v83
v_dot2c_f32_bf16 v96, s50, v84
v_dot2c_f32_bf16 v97, s51, v84
v_dot2c_f32_bf16 v98, s50, v85
v_dot2c_f32_bf16 v99, s51, v85
v_dot2c_f32_bf16 v100, s50, v86
v_dot2c_f32_bf16 v101, s51, v86
v_dot2c_f32_bf16 v102, s50, v87
v_dot2c_f32_bf16 v103, s51, v87
v_dot2c_f32_bf16 v96, s50, v88
v_dot2c_f32_bf16 v97, s51, v88
v_dot2c_f32_bf16 v98, s50, v89
v_dot2c_f32_bf16 v99, s51, v89
v_dot2c_f32_bf16 v100, s50, v90
v_dot2c_f32_bf16 v101, s51, v90
v_dot2c_f32_bf16 v102, s50, v91
v_dot2c_f32_bf16 v103, s51, v91
v_dot2c_f32_bf16 v96, s50, v92
v_dot2c_f32_bf16 v97, s51, v92
v_dot2c_f32_bf16 v98, s50, v93
v_dot2c_f32_bf16 v99, s51, v93
v_dot2c_f32_bf16 v100, s50, v94
v_dot2c_f32_bf16 v101, s51, v94
v_dot2c_f32_bf16 v102, s50, v95
v_dot2c_f32_bf16 v103, s51, v95
v_dot2c_f32_bf16 v96, s50, v52
v_dot2c_f32_bf16 v97, s51, v52
v_dot2c_f32_bf16 v98, s50, v53
v_dot2c_f32_bf16 v99, s51, v53
v_dot2c_f32_bf16 v100, s50, v54
v_dot2c_f32_bf16 v101, s51, v54
v_dot2c_f32_bf16 v102, s50, v55
v_dot2c_f32_bf16 v103, s51, v55
v_cvt_pk_bf16_f32 v48, v96, v97
v_cvt_pk_bf16_f32 v49, v98, v99
v_cvt_pk_bf16_f32 v50, v100, v101
v_cvt_pk_bf16_f32 v51, v102, v103
buffer_store_dwordx4 v[48:51], v45, s[32:35], s55 offen
L_ldone:
s_endpgm
.p2align 12
L_compute:
s_lshr_b32 s7, s6, 2
s_and_b32 s8, s6, 3
s_lshl_b32 s47, s4, 2
s_add_u32 s47, s47, s5
s_cmp_eq_u32 s4, 0
s_cselect_b32 s58, 3, 3
s_and_b32 s58, s58, s5
s_add_u32 s58, s58, s8
s_and_b32 s58, s58, 3
s_lshl_b32 s48, s47, 2
s_add_u32 s48, s48, s58
s_lshl_b32 s48, s48, 18
s_add_u32 s48, s48, 4194304
s_lshl_b32 s49, s47, 19
s_add_u32 s49, s49, 12582912
s_mov_b32 s38, 256
s_mov_b32 s39, 0x00020000
v_and_b32 v14, 31, v0
v_lshrrev_b32 v15, 5, v0
v_lshlrev_b32 v12, 4, v0
v_bfe_u32 v16, v0, 1, 3
v_xor_b32 v16, v16, v15
v_lshlrev_b32 v16, 4, v16
v_lshl_or_b32 v16, v14, 7, v16
s_lshl_b32 s44, s9, 12
v_add_u32 v2, s44, v16
s_add_u32 s44, s44, 131072
v_add_u32 v13, s44, v12
s_lshl_b32 s44, s9, 11
s_add_u32 s44, s44, 131072
v_add_u32 v248, s44, v12
v_xor_b32 v3, 32, v2
v_xor_b32 v4, 64, v2
v_xor_b32 v5, 96, v2
v_bfe_u32 v16, v0, 2, 2
v_and_b32 v17, 1, v0
v_bfe_u32 v18, v0, 1, 1
v_lshlrev_b32 v17, 4, v17
v_lshl_or_b32 v17, v18, 3, v17
v_bfe_u32 v18, v0, 4, 1
v_lshl_or_b32 v17, v18, 5, v17
v_lshl_or_b32 v18, v15, 3, v16
v_lshl_or_b32 v19, v18, 8, v17
v_lshl_or_b32 v19, v16, 6, v19
v_add_u32 v6, 0x4000, v19
v_xor_b32 v7, 64, v6
v_xor_b32 v8, 128, v6
v_xor_b32 v9, 192, v6
v_lshl_or_b32 v19, v18, 7, v17
v_lshrrev_b32 v16, 1, v16
v_lshl_or_b32 v19, v16, 6, v19
v_add_u32 v10, 98304, v19
v_xor_b32 v11, 64, v10
v_mov_b32 v14, 0
v_mov_b32 v15, 1
s_lshl_b32 s44, s9, 16
s_add_u32 s51, s48, s44
s_lshl_b32 s44, s7, 10
s_add_u32 s51, s51, s44
s_mov_b32 s53, 0x3e0293ee
s_lshl_b32 s59, s47, 5
v_mov_b32 v249, 0x10001
s_waitcnt lgkmcnt(0)
s_cmp_eq_u32 s9, 0
s_cbranch_scc1 L_pgpad0
s_cmp_eq_u32 s9, 1
s_cbranch_scc1 L_pgpad1
s_cmp_eq_u32 s9, 2
s_cbranch_scc1 L_pgpad2
L_pgret:
s_barrier
ds_read_b128 v[32:35], v2 offset:0
ds_read_b64_tr_b16 v[16:17], v6 offset:0
ds_read_b64_tr_b16 v[18:19], v6 offset:1024
ds_read_b64_tr_b16 v[20:21], v7 offset:0
ds_read_b64_tr_b16 v[22:23], v7 offset:1024
ds_read_b64_tr_b16 v[24:25], v8 offset:0
ds_read_b64_tr_b16 v[26:27], v8 offset:1024
ds_read_b64_tr_b16 v[28:29], v9 offset:0
ds_read_b64_tr_b16 v[30:31], v9 offset:1024
ds_read_b128 v[36:39], v3 offset:0
s_waitcnt lgkmcnt(5)
v_mfma_f32_32x32x16_bf16 v[72:87], v[16:19], v[32:35], 0
ds_read_b64_tr_b16 v[16:17], v6 offset:4096
ds_read_b64_tr_b16 v[18:19], v6 offset:5120
v_mfma_f32_32x32x16_bf16 v[88:103], v[20:23], v[32:35], 0
ds_read_b64_tr_b16 v[20:21], v7 offset:4096
ds_read_b64_tr_b16 v[22:23], v7 offset:5120
s_waitcnt lgkmcnt(5)
v_mfma_f32_32x32x16_bf16 v[104:119], v[24:27], v[32:35], 0
ds_read_b64_tr_b16 v[24:25], v8 offset:4096
ds_read_b64_tr_b16 v[26:27], v8 offset:5120
v_mfma_f32_32x32x16_bf16 v[120:135], v[28:31], v[32:35], 0
ds_read_b64_tr_b16 v[28:29], v9 offset:4096
ds_read_b64_tr_b16 v[30:31], v9 offset:5120
ds_read_b128 v[32:35], v4 offset:0
s_waitcnt lgkmcnt(5)
v_mfma_f32_32x32x16_bf16 v[72:87], v[16:19], v[36:39], v[72:87]
ds_read_b64_tr_b16 v[16:17], v6 offset:8192
ds_read_b64_tr_b16 v[18:19], v6 offset:9216
v_mfma_f32_32x32x16_bf16 v[88:103], v[20:23], v[36:39], v[88:103]
ds_read_b64_tr_b16 v[20:21], v7 offset:8192
ds_read_b64_tr_b16 v[22:23], v7 offset:9216
s_waitcnt lgkmcnt(5)
v_mfma_f32_32x32x16_bf16 v[104:119], v[24:27], v[36:39], v[104:119]
ds_read_b64_tr_b16 v[24:25], v8 offset:8192
ds_read_b64_tr_b16 v[26:27], v8 offset:9216
v_mfma_f32_32x32x16_bf16 v[120:135], v[28:31], v[36:39], v[120:135]
ds_read_b64_tr_b16 v[28:29], v9 offset:8192
ds_read_b64_tr_b16 v[30:31], v9 offset:9216
ds_read_b128 v[36:39], v5 offset:0
s_waitcnt lgkmcnt(5)
v_mfma_f32_32x32x16_bf16 v[72:87], v[16:19], v[32:35], v[72:87]
ds_read_b64_tr_b16 v[16:17], v6 offset:12288
ds_read_b64_tr_b16 v[18:19], v6 offset:13312
v_add_u32 v6, 32768, v6
v_add_u32 v2, 32768, v2
v_mfma_f32_32x32x16_bf16 v[88:103], v[20:23], v[32:35], v[88:103]
ds_read_b64_tr_b16 v[20:21], v7 offset:12288
ds_read_b64_tr_b16 v[22:23], v7 offset:13312
v_add_u32 v7, 32768, v7
v_add_u32 v3, 32768, v3
s_waitcnt lgkmcnt(5)
v_mfma_f32_32x32x16_bf16 v[104:119], v[24:27], v[32:35], v[104:119]
ds_read_b64_tr_b16 v[24:25], v8 offset:12288
ds_read_b64_tr_b16 v[26:27], v8 offset:13312
v_add_u32 v8, 32768, v8
v_add_u32 v4, 32768, v4
v_mfma_f32_32x32x16_bf16 v[120:135], v[28:31], v[32:35], v[120:135]
ds_read_b64_tr_b16 v[28:29], v9 offset:12288
ds_read_b64_tr_b16 v[30:31], v9 offset:13312
v_add_u32 v9, 32768, v9
v_add_u32 v5, 32768, v5
s_waitcnt lgkmcnt(4)
v_mfma_f32_32x32x16_bf16 v[72:87], v[16:19], v[36:39], v[72:87]
s_barrier
ds_read_b128 v[32:35], v2 offset:0
ds_read_b64_tr_b16 v[16:17], v6 offset:0
ds_read_b64_tr_b16 v[18:19], v6 offset:1024
v_mfma_f32_32x32x16_bf16 v[88:103], v[20:23], v[36:39], v[88:103]
ds_read_b64_tr_b16 v[20:21], v7 offset:0
ds_read_b64_tr_b16 v[22:23], v7 offset:1024
s_waitcnt lgkmcnt(5)
v_mfma_f32_32x32x16_bf16 v[104:119], v[24:27], v[36:39], v[104:119]
ds_read_b64_tr_b16 v[24:25], v8 offset:0
ds_read_b64_tr_b16 v[26:27], v8 offset:1024
v_mfma_f32_32x32x16_bf16 v[120:135], v[28:31], v[36:39], v[120:135]
ds_read_b64_tr_b16 v[28:29], v9 offset:0
ds_read_b64_tr_b16 v[30:31], v9 offset:1024
s_cmp_lg_u32 s9, 0
s_cbranch_scc1 L_nga
s_mov_b64 exec, 1
buffer_atomic_add v15, v14, s[36:39], s59 offen sc1
s_mov_b64 exec, -1
L_nga:
s_mov_b32 s52, 32768
s_mov_b32 s55, 7
L_cloop:
ds_read_b128 v[36:39], v3 offset:0
s_waitcnt lgkmcnt(5)
v_mfma_f32_32x32x16_bf16 v[72:87], v[16:19], v[32:35], v[72:87]
ds_read_b64_tr_b16 v[16:17], v6 offset:4096
ds_read_b64_tr_b16 v[18:19], v6 offset:5120
v_mfma_f32_32x32x16_bf16 v[88:103], v[20:23], v[32:35], v[88:103]
ds_read_b64_tr_b16 v[20:21], v7 offset:4096
ds_read_b64_tr_b16 v[22:23], v7 offset:5120
s_add_u32 s50, s52, 0x8000
s_and_b32 s45, s50, 0x1ffff
s_waitcnt lgkmcnt(5)
v_mfma_f32_32x32x16_bf16 v[104:119], v[24:27], v[32:35], v[104:119]
ds_read_b64_tr_b16 v[24:25], v8 offset:4096
ds_read_b64_tr_b16 v[26:27], v8 offset:5120
v_mfma_f32_32x32x16_bf16 v[120:135], v[28:31], v[32:35], v[120:135]
ds_read_b64_tr_b16 v[28:29], v9 offset:4096
ds_read_b64_tr_b16 v[30:31], v9 offset:5120
s_sub_u32 s50, s45, s52
s_mov_b32 s52, s45
ds_read_b128 v[32:35], v4 offset:0
s_waitcnt lgkmcnt(5)
v_mfma_f32_32x32x16_bf16 v[72:87], v[16:19], v[36:39], v[72:87]
ds_read_b64_tr_b16 v[16:17], v6 offset:8192
ds_read_b64_tr_b16 v[18:19], v6 offset:9216
v_mfma_f32_32x32x16_bf16 v[88:103], v[20:23], v[36:39], v[88:103]
ds_read_b64_tr_b16 v[20:21], v7 offset:8192
ds_read_b64_tr_b16 v[22:23], v7 offset:9216
s_sub_u32 s55, s55, 1
s_cmp_lg_u32 s55, 0
s_waitcnt lgkmcnt(5)
v_mfma_f32_32x32x16_bf16 v[104:119], v[24:27], v[36:39], v[104:119]
ds_read_b64_tr_b16 v[24:25], v8 offset:8192
ds_read_b64_tr_b16 v[26:27], v8 offset:9216
v_mfma_f32_32x32x16_bf16 v[120:135], v[28:31], v[36:39], v[120:135]
ds_read_b64_tr_b16 v[28:29], v9 offset:8192
ds_read_b64_tr_b16 v[30:31], v9 offset:9216
ds_read_b128 v[36:39], v5 offset:0
s_waitcnt lgkmcnt(5)
v_mfma_f32_32x32x16_bf16 v[72:87], v[16:19], v[32:35], v[72:87]
ds_read_b64_tr_b16 v[16:17], v6 offset:12288
ds_read_b64_tr_b16 v[18:19], v6 offset:13312
v_add_u32 v6, s50, v6
v_add_u32 v2, s50, v2
v_mfma_f32_32x32x16_bf16 v[88:103], v[20:23], v[32:35], v[88:103]
ds_read_b64_tr_b16 v[20:21], v7 offset:12288
ds_read_b64_tr_b16 v[22:23], v7 offset:13312
v_add_u32 v7, s50, v7
v_add_u32 v3, s50, v3
s_waitcnt lgkmcnt(5)
v_mfma_f32_32x32x16_bf16 v[104:119], v[24:27], v[32:35], v[104:119]
ds_read_b64_tr_b16 v[24:25], v8 offset:12288
ds_read_b64_tr_b16 v[26:27], v8 offset:13312
v_add_u32 v8, s50, v8
v_add_u32 v4, s50, v4
v_mfma_f32_32x32x16_bf16 v[120:135], v[28:31], v[32:35], v[120:135]
ds_read_b64_tr_b16 v[28:29], v9 offset:12288
ds_read_b64_tr_b16 v[30:31], v9 offset:13312
v_add_u32 v9, s50, v9
v_add_u32 v5, s50, v5
s_waitcnt lgkmcnt(4)
v_mfma_f32_32x32x16_bf16 v[72:87], v[16:19], v[36:39], v[72:87]
s_barrier
ds_read_b128 v[32:35], v2 offset:0
ds_read_b64_tr_b16 v[16:17], v6 offset:0
ds_read_b64_tr_b16 v[18:19], v6 offset:1024
v_mfma_f32_32x32x16_bf16 v[88:103], v[20:23], v[36:39], v[88:103]
ds_read_b64_tr_b16 v[20:21], v7 offset:0
ds_read_b64_tr_b16 v[22:23], v7 offset:1024
s_waitcnt lgkmcnt(5)
v_mfma_f32_32x32x16_bf16 v[104:119], v[24:27], v[36:39], v[104:119]
ds_read_b64_tr_b16 v[24:25], v8 offset:0
ds_read_b64_tr_b16 v[26:27], v8 offset:1024
v_mfma_f32_32x32x16_bf16 v[120:135], v[28:31], v[36:39], v[120:135]
ds_read_b64_tr_b16 v[28:29], v9 offset:0
ds_read_b64_tr_b16 v[30:31], v9 offset:1024
s_cbranch_scc1 L_cloop
ds_read_b128 v[36:39], v3 offset:0
s_waitcnt lgkmcnt(5)
v_mfma_f32_32x32x16_bf16 v[72:87], v[16:19], v[32:35], v[72:87]
ds_read_b64_tr_b16 v[16:17], v6 offset:4096
ds_read_b64_tr_b16 v[18:19], v6 offset:5120
v_mfma_f32_32x32x16_bf16 v[88:103], v[20:23], v[32:35], v[88:103]
ds_read_b64_tr_b16 v[20:21], v7 offset:4096
ds_read_b64_tr_b16 v[22:23], v7 offset:5120
s_waitcnt lgkmcnt(5)
v_mfma_f32_32x32x16_bf16 v[104:119], v[24:27], v[32:35], v[104:119]
ds_read_b64_tr_b16 v[24:25], v8 offset:4096
ds_read_b64_tr_b16 v[26:27], v8 offset:5120
v_mfma_f32_32x32x16_bf16 v[120:135], v[28:31], v[32:35], v[120:135]
ds_read_b64_tr_b16 v[28:29], v9 offset:4096
ds_read_b64_tr_b16 v[30:31], v9 offset:5120
ds_read_b128 v[32:35], v4 offset:0
s_waitcnt lgkmcnt(5)
v_mfma_f32_32x32x16_bf16 v[72:87], v[16:19], v[36:39], v[72:87]
ds_read_b64_tr_b16 v[16:17], v6 offset:8192
ds_read_b64_tr_b16 v[18:19], v6 offset:9216
v_mfma_f32_32x32x16_bf16 v[88:103], v[20:23], v[36:39], v[88:103]
ds_read_b64_tr_b16 v[20:21], v7 offset:8192
ds_read_b64_tr_b16 v[22:23], v7 offset:9216
s_waitcnt lgkmcnt(5)
v_mfma_f32_32x32x16_bf16 v[104:119], v[24:27], v[36:39], v[104:119]
ds_read_b64_tr_b16 v[24:25], v8 offset:8192
ds_read_b64_tr_b16 v[26:27], v8 offset:9216
v_mfma_f32_32x32x16_bf16 v[120:135], v[28:31], v[36:39], v[120:135]
ds_read_b64_tr_b16 v[28:29], v9 offset:8192
ds_read_b64_tr_b16 v[30:31], v9 offset:9216
ds_read_b128 v[36:39], v5 offset:0
s_waitcnt lgkmcnt(5)
v_mfma_f32_32x32x16_bf16 v[72:87], v[16:19], v[32:35], v[72:87]
ds_read_b64_tr_b16 v[16:17], v6 offset:12288
ds_read_b64_tr_b16 v[18:19], v6 offset:13312
v_add_u32 v6, 131072, v6
v_add_u32 v2, 131072, v2
v_mfma_f32_32x32x16_bf16 v[88:103], v[20:23], v[32:35], v[88:103]
ds_read_b64_tr_b16 v[20:21], v7 offset:12288
ds_read_b64_tr_b16 v[22:23], v7 offset:13312
v_add_u32 v7, 131072, v7
v_add_u32 v3, 131072, v3
s_waitcnt lgkmcnt(5)
v_mfma_f32_32x32x16_bf16 v[104:119], v[24:27], v[32:35], v[104:119]
ds_read_b64_tr_b16 v[24:25], v8 offset:12288
ds_read_b64_tr_b16 v[26:27], v8 offset:13312
v_add_u32 v8, 131072, v8
v_add_u32 v4, 131072, v4
v_mfma_f32_32x32x16_bf16 v[120:135], v[28:31], v[32:35], v[120:135]
ds_read_b64_tr_b16 v[28:29], v9 offset:12288
ds_read_b64_tr_b16 v[30:31], v9 offset:13312
v_add_u32 v9, 131072, v9
v_add_u32 v5, 131072, v5
s_waitcnt lgkmcnt(4)
v_mfma_f32_32x32x16_bf16 v[72:87], v[16:19], v[36:39], v[72:87]
s_barrier
ds_read_b128 v[40:43], v2 offset:0
ds_read_b128 v[44:47], v3 offset:0
v_mfma_f32_32x32x16_bf16 v[88:103], v[20:23], v[36:39], v[88:103]
ds_read_b128 v[48:51], v4 offset:0
ds_read_b128 v[52:55], v5 offset:0
s_waitcnt lgkmcnt(4)
v_mfma_f32_32x32x16_bf16 v[104:119], v[24:27], v[36:39], v[104:119]
ds_read_b128 v[56:59], v2 offset:16384
ds_read_b128 v[60:63], v3 offset:16384
v_mfma_f32_32x32x16_bf16 v[120:135], v[28:31], v[36:39], v[120:135]
ds_read_b128 v[64:67], v4 offset:16384
ds_read_b128 v[68:71], v5 offset:16384
v_cvt_pk_bf16_f32 v200, v72, v73
v_cvt_pk_bf16_f32 v201, v74, v75
v_cvt_pk_bf16_f32 v202, v76, v77
v_cvt_pk_bf16_f32 v203, v78, v79
v_cvt_pk_bf16_f32 v204, v80, v81
v_cvt_pk_bf16_f32 v205, v82, v83
v_cvt_pk_bf16_f32 v206, v84, v85
v_cvt_pk_bf16_f32 v207, v86, v87
s_waitcnt lgkmcnt(7)
v_mfma_f32_32x32x16_bf16 v[136:151], v[40:43], v[200:203], 0
s_waitcnt lgkmcnt(6)
v_mfma_f32_32x32x16_bf16 v[136:151], v[44:47], v[204:207], v[136:151]
v_cvt_pk_bf16_f32 v208, v88, v89
v_cvt_pk_bf16_f32 v209, v90, v91
v_cvt_pk_bf16_f32 v210, v92, v93
v_cvt_pk_bf16_f32 v211, v94, v95
v_cvt_pk_bf16_f32 v212, v96, v97
v_cvt_pk_bf16_f32 v213, v98, v99
v_cvt_pk_bf16_f32 v214, v100, v101
v_cvt_pk_bf16_f32 v215, v102, v103
s_waitcnt lgkmcnt(5)
v_mfma_f32_32x32x16_bf16 v[136:151], v[48:51], v[208:211], v[136:151]
s_waitcnt lgkmcnt(4)
v_mfma_f32_32x32x16_bf16 v[136:151], v[52:55], v[212:215], v[136:151]
v_cvt_pk_bf16_f32 v216, v104, v105
v_cvt_pk_bf16_f32 v217, v106, v107
v_cvt_pk_bf16_f32 v218, v108, v109
v_cvt_pk_bf16_f32 v219, v110, v111
v_cvt_pk_bf16_f32 v220, v112, v113
v_cvt_pk_bf16_f32 v221, v114, v115
v_cvt_pk_bf16_f32 v222, v116, v117
v_cvt_pk_bf16_f32 v223, v118, v119
s_waitcnt lgkmcnt(3)
v_mfma_f32_32x32x16_bf16 v[136:151], v[56:59], v[216:219], v[136:151]
s_waitcnt lgkmcnt(2)
v_mfma_f32_32x32x16_bf16 v[136:151], v[60:63], v[220:223], v[136:151]
v_cvt_pk_bf16_f32 v224, v120, v121
v_cvt_pk_bf16_f32 v225, v122, v123
v_cvt_pk_bf16_f32 v226, v124, v125
v_cvt_pk_bf16_f32 v227, v126, v127
v_cvt_pk_bf16_f32 v228, v128, v129
v_cvt_pk_bf16_f32 v229, v130, v131
v_cvt_pk_bf16_f32 v230, v132, v133
v_cvt_pk_bf16_f32 v231, v134, v135
s_waitcnt lgkmcnt(1)
v_mfma_f32_32x32x16_bf16 v[136:151], v[64:67], v[224:227], v[136:151]
s_waitcnt lgkmcnt(0)
v_mfma_f32_32x32x16_bf16 v[136:151], v[68:71], v[228:231], v[136:151]
v_subrev_u32 v2, 98304, v2
v_subrev_u32 v3, 98304, v3
v_subrev_u32 v4, 98304, v4
v_subrev_u32 v5, 98304, v5
v_subrev_u32 v6, 98304, v6
v_subrev_u32 v7, 98304, v7
v_subrev_u32 v8, 98304, v8
v_subrev_u32 v9, 98304, v9
s_nop 3
v_max3_f32 v152, v136, v137, v138
v_max3_f32 v153, v139, v140, v141
v_max3_f32 v152, v152, v142, v143
v_max3_f32 v153, v153, v144, v145
v_max3_f32 v152, v152, v146, v147
v_max3_f32 v153, v153, v148, v149
v_max3_f32 v152, v152, v150, v151
v_max_f32 v152, v152, v153
v_mov_b32 v153, v152
s_nop 1
v_permlane32_swap_b32 v152, v153
v_max_f32 v152, v152, v153
v_mul_f32 v152, s53, v152
v_fma_f32 v168, v136, s53, -v152
v_fma_f32 v169, v137, s53, -v152
v_exp_f32 v168, v168
v_fma_f32 v170, v138, s53, -v152
v_exp_f32 v169, v169
v_fma_f32 v171, v139, s53, -v152
v_exp_f32 v170, v170
v_fma_f32 v172, v140, s53, -v152
v_exp_f32 v171, v171
v_fma_f32 v173, v141, s53, -v152
v_exp_f32 v172, v172
v_fma_f32 v174, v142, s53, -v152
v_exp_f32 v173, v173
v_fma_f32 v175, v143, s53, -v152
v_exp_f32 v174, v174
v_fma_f32 v176, v144, s53, -v152
v_exp_f32 v175, v175
v_fma_f32 v177, v145, s53, -v152
v_exp_f32 v176, v176
v_fma_f32 v178, v146, s53, -v152
v_exp_f32 v177, v177
v_fma_f32 v179, v147, s53, -v152
v_exp_f32 v178, v178
v_fma_f32 v180, v148, s53, -v152
v_exp_f32 v179, v179
v_fma_f32 v181, v149, s53, -v152
v_exp_f32 v180, v180
v_fma_f32 v182, v150, s53, -v152
v_exp_f32 v181, v181
v_fma_f32 v183, v151, s53, -v152
v_exp_f32 v182, v182
v_exp_f32 v183, v183
v_add_f32 v154, v168, v172
v_add_f32 v155, v169, v173
v_add_f32 v156, v170, v174
v_add_f32 v157, v171, v175
v_add_f32 v154, v154, v176
v_add_f32 v155, v155, v177
v_add_f32 v156, v156, v178
v_add_f32 v157, v157, v179
v_add_f32 v154, v154, v180
v_add_f32 v155, v155, v181
v_add_f32 v156, v156, v182
v_add_f32 v157, v157, v183
v_add_f32 v154, v154, v155
v_add_f32 v156, v156, v157
v_add_f32 v154, v154, v156
v_mov_b32 v153, v154
s_nop 1
v_permlane32_swap_b32 v154, v153
v_add_f32 v154, v154, v153
v_rcp_f32 v154, v154
s_nop 0
v_mul_f32 v168, v168, v154
v_mul_f32 v169, v169, v154
v_cvt_pk_bf16_f32 v232, v168, v169
v_mul_f32 v170, v170, v154
v_mul_f32 v171, v171, v154
v_cvt_pk_bf16_f32 v233, v170, v171
v_mul_f32 v172, v172, v154
v_mul_f32 v173, v173, v154
v_cvt_pk_bf16_f32 v234, v172, v173
v_mul_f32 v174, v174, v154
v_mul_f32 v175, v175, v154
v_cvt_pk_bf16_f32 v235, v174, v175
v_mul_f32 v176, v176, v154
v_mul_f32 v177, v177, v154
v_cvt_pk_bf16_f32 v236, v176, v177
v_mul_f32 v178, v178, v154
v_mul_f32 v179, v179, v154
v_cvt_pk_bf16_f32 v237, v178, v179
v_mul_f32 v180, v180, v154
v_mul_f32 v181, v181, v154
v_cvt_pk_bf16_f32 v238, v180, v181
v_mul_f32 v182, v182, v154
v_mul_f32 v183, v183, v154
v_cvt_pk_bf16_f32 v239, v182, v183
ds_write_b128 v13, v[232:235] offset:0
ds_write_b128 v13, v[236:239] offset:1024
s_waitcnt lgkmcnt(0)
s_barrier
ds_read_b128 v[40:43], v2 offset:0
ds_read_b64_tr_b16 v[16:17], v6 offset:0
ds_read_b64_tr_b16 v[18:19], v6 offset:1024
ds_read_b64_tr_b16 v[20:21], v7 offset:0
ds_read_b64_tr_b16 v[22:23], v7 offset:1024
ds_read_b64_tr_b16 v[24:25], v8 offset:0
ds_read_b64_tr_b16 v[26:27], v8 offset:1024
ds_read_b64_tr_b16 v[28:29], v9 offset:0
ds_read_b64_tr_b16 v[30:31], v9 offset:1024
ds_read_b128 v[44:47], v3 offset:0
s_waitcnt lgkmcnt(5)
v_mfma_f32_32x32x16_bf16 v[72:87], v[40:43], v[16:19], 0
ds_read_b64_tr_b16 v[16:17], v6 offset:4096
ds_read_b64_tr_b16 v[18:19], v6 offset:5120
v_mfma_f32_32x32x16_bf16 v[88:103], v[40:43], v[20:23], 0
ds_read_b64_tr_b16 v[20:21], v7 offset:4096
ds_read_b64_tr_b16 v[22:23], v7 offset:5120
s_waitcnt lgkmcnt(5)
v_mfma_f32_32x32x16_bf16 v[104:119], v[40:43], v[24:27], 0
ds_read_b64_tr_b16 v[24:25], v8 offset:4096
ds_read_b64_tr_b16 v[26:27], v8 offset:5120
v_mfma_f32_32x32x16_bf16 v[120:135], v[40:43], v[28:31], 0
ds_read_b64_tr_b16 v[28:29], v9 offset:4096
ds_read_b64_tr_b16 v[30:31], v9 offset:5120
ds_read_b128 v[48:51], v4 offset:0
s_waitcnt lgkmcnt(5)
v_mfma_f32_32x32x16_bf16 v[72:87], v[44:47], v[16:19], v[72:87]
ds_read_b64_tr_b16 v[16:17], v6 offset:8192
ds_read_b64_tr_b16 v[18:19], v6 offset:9216
v_mfma_f32_32x32x16_bf16 v[88:103], v[44:47], v[20:23], v[88:103]
ds_read_b64_tr_b16 v[20:21], v7 offset:8192
ds_read_b64_tr_b16 v[22:23], v7 offset:9216
s_waitcnt lgkmcnt(5)
v_mfma_f32_32x32x16_bf16 v[104:119], v[44:47], v[24:27], v[104:119]
ds_read_b64_tr_b16 v[24:25], v8 offset:8192
ds_read_b64_tr_b16 v[26:27], v8 offset:9216
v_mfma_f32_32x32x16_bf16 v[120:135], v[44:47], v[28:31], v[120:135]
ds_read_b64_tr_b16 v[28:29], v9 offset:8192
ds_read_b64_tr_b16 v[30:31], v9 offset:9216
ds_read_b128 v[52:55], v5 offset:0
s_waitcnt lgkmcnt(5)
v_mfma_f32_32x32x16_bf16 v[72:87], v[48:51], v[16:19], v[72:87]
ds_read_b64_tr_b16 v[16:17], v6 offset:12288
ds_read_b64_tr_b16 v[18:19], v6 offset:13312
v_add_u32 v6, 32768, v6
v_add_u32 v2, 32768, v2
v_mfma_f32_32x32x16_bf16 v[88:103], v[48:51], v[20:23], v[88:103]
ds_read_b64_tr_b16 v[20:21], v7 offset:12288
ds_read_b64_tr_b16 v[22:23], v7 offset:13312
v_add_u32 v7, 32768, v7
v_add_u32 v3, 32768, v3
s_waitcnt lgkmcnt(5)
v_mfma_f32_32x32x16_bf16 v[104:119], v[48:51], v[24:27], v[104:119]
ds_read_b64_tr_b16 v[24:25], v8 offset:12288
ds_read_b64_tr_b16 v[26:27], v8 offset:13312
v_add_u32 v8, 32768, v8
v_add_u32 v4, 32768, v4
v_mfma_f32_32x32x16_bf16 v[120:135], v[48:51], v[28:31], v[120:135]
ds_read_b64_tr_b16 v[28:29], v9 offset:12288
ds_read_b64_tr_b16 v[30:31], v9 offset:13312
v_add_u32 v9, 32768, v9
v_add_u32 v5, 32768, v5
s_waitcnt lgkmcnt(4)
v_mfma_f32_32x32x16_bf16 v[72:87], v[52:55], v[16:19], v[72:87]
s_barrier
ds_read_b128 v[56:59], v2 offset:0
ds_read_b64_tr_b16 v[16:17], v6 offset:0
ds_read_b64_tr_b16 v[18:19], v6 offset:1024
v_mfma_f32_32x32x16_bf16 v[88:103], v[52:55], v[20:23], v[88:103]
ds_read_b64_tr_b16 v[20:21], v7 offset:0
ds_read_b64_tr_b16 v[22:23], v7 offset:1024
s_waitcnt lgkmcnt(5)
v_mfma_f32_32x32x16_bf16 v[104:119], v[52:55], v[24:27], v[104:119]
ds_read_b64_tr_b16 v[24:25], v8 offset:0
ds_read_b64_tr_b16 v[26:27], v8 offset:1024
v_mfma_f32_32x32x16_bf16 v[120:135], v[52:55], v[28:31], v[120:135]
ds_read_b64_tr_b16 v[28:29], v9 offset:0
ds_read_b64_tr_b16 v[30:31], v9 offset:1024
ds_read_b128 v[60:63], v3 offset:0
s_waitcnt lgkmcnt(5)
v_mfma_f32_32x32x16_bf16 v[72:87], v[56:59], v[16:19], v[72:87]
s_branch L_pg1
.p2align 12
L_pgpad1:
s_branch L_pgret
L_pg1:
ds_read_b64_tr_b16 v[16:17], v6 offset:4096
ds_read_b64_tr_b16 v[18:19], v6 offset:5120
v_mfma_f32_32x32x16_bf16 v[88:103], v[56:59], v[20:23], v[88:103]
ds_read_b64_tr_b16 v[20:21], v7 offset:4096
ds_read_b64_tr_b16 v[22:23], v7 offset:5120
s_waitcnt lgkmcnt(5)
v_mfma_f32_32x32x16_bf16 v[104:119], v[56:59], v[24:27], v[104:119]
ds_read_b64_tr_b16 v[24:25], v8 offset:4096
ds_read_b64_tr_b16 v[26:27], v8 offset:5120
v_mfma_f32_32x32x16_bf16 v[120:135], v[56:59], v[28:31], v[120:135]
ds_read_b64_tr_b16 v[28:29], v9 offset:4096
ds_read_b64_tr_b16 v[30:31], v9 offset:5120
ds_read_b128 v[64:67], v4 offset:0
s_waitcnt lgkmcnt(5)
v_mfma_f32_32x32x16_bf16 v[72:87], v[60:63], v[16:19], v[72:87]
ds_read_b64_tr_b16 v[16:17], v6 offset:8192
ds_read_b64_tr_b16 v[18:19], v6 offset:9216
v_mfma_f32_32x32x16_bf16 v[88:103], v[60:63], v[20:23], v[88:103]
ds_read_b64_tr_b16 v[20:21], v7 offset:8192
ds_read_b64_tr_b16 v[22:23], v7 offset:9216
s_waitcnt lgkmcnt(5)
v_mfma_f32_32x32x16_bf16 v[104:119], v[60:63], v[24:27], v[104:119]
ds_read_b64_tr_b16 v[24:25], v8 offset:8192
ds_read_b64_tr_b16 v[26:27], v8 offset:9216
v_mfma_f32_32x32x16_bf16 v[120:135], v[60:63], v[28:31], v[120:135]
ds_read_b64_tr_b16 v[28:29], v9 offset:8192
ds_read_b64_tr_b16 v[30:31], v9 offset:9216
ds_read_b128 v[68:71], v5 offset:0
s_waitcnt lgkmcnt(5)
v_mfma_f32_32x32x16_bf16 v[72:87], v[64:67], v[16:19], v[72:87]
ds_read_b64_tr_b16 v[16:17], v6 offset:12288
ds_read_b64_tr_b16 v[18:19], v6 offset:13312
v_add_u32 v6, 32768, v6
v_add_u32 v2, 32768, v2
v_mfma_f32_32x32x16_bf16 v[88:103], v[64:67], v[20:23], v[88:103]
ds_read_b64_tr_b16 v[20:21], v7 offset:12288
ds_read_b64_tr_b16 v[22:23], v7 offset:13312
v_add_u32 v7, 32768, v7
v_add_u32 v3, 32768, v3
s_waitcnt lgkmcnt(5)
v_mfma_f32_32x32x16_bf16 v[104:119], v[64:67], v[24:27], v[104:119]
ds_read_b64_tr_b16 v[24:25], v8 offset:12288
ds_read_b64_tr_b16 v[26:27], v8 offset:13312
v_add_u32 v8, 32768, v8
v_add_u32 v4, 32768, v4
v_mfma_f32_32x32x16_bf16 v[120:135], v[64:67], v[28:31], v[120:135]
ds_read_b64_tr_b16 v[28:29], v9 offset:12288
ds_read_b64_tr_b16 v[30:31], v9 offset:13312
v_add_u32 v9, 32768, v9
v_add_u32 v5, 32768, v5
s_waitcnt lgkmcnt(4)
v_mfma_f32_32x32x16_bf16 v[72:87], v[68:71], v[16:19], v[72:87]
s_barrier
ds_read_b64_tr_b16 v[16:17], v10 offset:0
ds_read_b64_tr_b16 v[18:19], v10 offset:512
v_mfma_f32_32x32x16_bf16 v[88:103], v[68:71], v[20:23], v[88:103]
ds_read_b64_tr_b16 v[20:21], v11 offset:0
ds_read_b64_tr_b16 v[22:23], v11 offset:512
s_waitcnt lgkmcnt(4)
v_mfma_f32_32x32x16_bf16 v[104:119], v[68:71], v[24:27], v[104:119]
ds_read_b64_tr_b16 v[24:25], v10 offset:2048
ds_read_b64_tr_b16 v[26:27], v10 offset:2560
v_mfma_f32_32x32x16_bf16 v[120:135], v[68:71], v[28:31], v[120:135]
ds_read_b64_tr_b16 v[28:29], v11 offset:2048
ds_read_b64_tr_b16 v[30:31], v11 offset:2560
s_waitcnt lgkmcnt(4)
v_mfma_f32_32x32x16_bf16 v[168:183], v[40:43], v[16:19], 0
ds_read_b64_tr_b16 v[16:17], v10 offset:4096
ds_read_b64_tr_b16 v[18:19], v10 offset:4608
v_cvt_pk_bf16_f32 v200, v72, v73
v_cvt_pk_bf16_f32 v201, v74, v75
v_mfma_f32_32x32x16_bf16 v[184:199], v[40:43], v[20:23], 0
ds_read_b64_tr_b16 v[20:21], v11 offset:4096
ds_read_b64_tr_b16 v[22:23], v11 offset:4608
v_cvt_pk_bf16_f32 v202, v76, v77
v_cvt_pk_bf16_f32 v203, v78, v79
s_waitcnt lgkmcnt(4)
v_mfma_f32_32x32x16_bf16 v[168:183], v[44:47], v[24:27], v[168:183]
ds_read_b64_tr_b16 v[24:25], v10 offset:6144
ds_read_b64_tr_b16 v[26:27], v10 offset:6656
v_cvt_pk_bf16_f32 v204, v80, v81
v_cvt_pk_bf16_f32 v205, v82, v83
v_mfma_f32_32x32x16_bf16 v[184:199], v[44:47], v[28:31], v[184:199]
ds_read_b64_tr_b16 v[28:29], v11 offset:6144
ds_read_b64_tr_b16 v[30:31], v11 offset:6656
v_cvt_pk_bf16_f32 v206, v84, v85
v_cvt_pk_bf16_f32 v207, v86, v87
v_mfma_f32_32x32x16_bf16 v[136:151], v[200:203], v[232:235], 0
v_cvt_pk_bf16_f32 v208, v88, v89
v_cvt_pk_bf16_f32 v209, v90, v91
v_cvt_pk_bf16_f32 v210, v92, v93
v_cvt_pk_bf16_f32 v211, v94, v95
v_cvt_pk_bf16_f32 v212, v96, v97
v_cvt_pk_bf16_f32 v213, v98, v99
s_waitcnt lgkmcnt(4)
v_mfma_f32_32x32x16_bf16 v[168:183], v[48:51], v[16:19], v[168:183]
ds_read_b64_tr_b16 v[16:17], v10 offset:8192
ds_read_b64_tr_b16 v[18:19], v10 offset:8704
v_cvt_pk_bf16_f32 v214, v100, v101
v_cvt_pk_bf16_f32 v215, v102, v103
v_mfma_f32_32x32x16_bf16 v[136:151], v[204:207], v[236:239], v[136:151]
v_cvt_pk_bf16_f32 v216, v104, v105
v_cvt_pk_bf16_f32 v217, v106, v107
v_cvt_pk_bf16_f32 v218, v108, v109
v_cvt_pk_bf16_f32 v219, v110, v111
v_cvt_pk_bf16_f32 v220, v112, v113
v_cvt_pk_bf16_f32 v221, v114, v115
v_mfma_f32_32x32x16_bf16 v[184:199], v[48:51], v[20:23], v[184:199]
ds_read_b64_tr_b16 v[20:21], v11 offset:8192
ds_read_b64_tr_b16 v[22:23], v11 offset:8704
v_cvt_pk_bf16_f32 v222, v116, v117
v_cvt_pk_bf16_f32 v223, v118, v119
v_mfma_f32_32x32x16_bf16 v[152:167], v[208:211], v[232:235], 0
v_cvt_pk_bf16_f32 v224, v120, v121
v_cvt_pk_bf16_f32 v225, v122, v123
v_cvt_pk_bf16_f32 v226, v124, v125
v_cvt_pk_bf16_f32 v227, v126, v127
v_cvt_pk_bf16_f32 v228, v128, v129
v_cvt_pk_bf16_f32 v229, v130, v131
s_waitcnt lgkmcnt(4)
v_mfma_f32_32x32x16_bf16 v[168:183], v[52:55], v[24:27], v[168:183]
ds_read_b64_tr_b16 v[24:25], v10 offset:10240
ds_read_b64_tr_b16 v[26:27], v10 offset:10752
v_cvt_pk_bf16_f32 v230, v132, v133
v_cvt_pk_bf16_f32 v231, v134, v135
v_mfma_f32_32x32x16_bf16 v[152:167], v[212:215], v[236:239], v[152:167]
v_mfma_f32_32x32x16_bf16 v[184:199], v[52:55], v[28:31], v[184:199]
ds_read_b64_tr_b16 v[28:29], v11 offset:10240
ds_read_b64_tr_b16 v[30:31], v11 offset:10752
s_waitcnt lgkmcnt(4)
v_mfma_f32_32x32x16_bf16 v[168:183], v[56:59], v[16:19], v[168:183]
ds_read_b64_tr_b16 v[16:17], v10 offset:12288
ds_read_b64_tr_b16 v[18:19], v10 offset:12800
v_subrev_u32 v6, 98304, v6
v_subrev_u32 v2, 98304, v2
v_mfma_f32_32x32x16_bf16 v[184:199], v[56:59], v[20:23], v[184:199]
ds_read_b64_tr_b16 v[20:21], v11 offset:12288
ds_read_b64_tr_b16 v[22:23], v11 offset:12800
v_subrev_u32 v7, 98304, v7
v_subrev_u32 v3, 98304, v3
s_waitcnt lgkmcnt(4)
v_mfma_f32_32x32x16_bf16 v[168:183], v[60:63], v[24:27], v[168:183]
ds_read_b64_tr_b16 v[24:25], v10 offset:14336
ds_read_b64_tr_b16 v[26:27], v10 offset:14848
v_subrev_u32 v8, 98304, v8
v_subrev_u32 v4, 98304, v4
v_mfma_f32_32x32x16_bf16 v[184:199], v[60:63], v[28:31], v[184:199]
ds_read_b64_tr_b16 v[28:29], v11 offset:14336
ds_read_b64_tr_b16 v[30:31], v11 offset:14848
v_subrev_u32 v9, 98304, v9
v_subrev_u32 v5, 98304, v5
s_waitcnt lgkmcnt(4)
v_mfma_f32_32x32x16_bf16 v[168:183], v[64:67], v[16:19], v[168:183]
s_barrier
ds_read_b128 v[32:35], v2 offset:0
ds_read_b64_tr_b16 v[16:17], v6 offset:0
ds_read_b64_tr_b16 v[18:19], v6 offset:1024
v_mfma_f32_32x32x16_bf16 v[184:199], v[64:67], v[20:23], v[184:199]
ds_read_b64_tr_b16 v[20:21], v7 offset:0
ds_read_b64_tr_b16 v[22:23], v7 offset:1024
s_waitcnt lgkmcnt(5)
v_mfma_f32_32x32x16_bf16 v[168:183], v[68:71], v[24:27], v[168:183]
ds_read_b64_tr_b16 v[24:25], v8 offset:0
ds_read_b64_tr_b16 v[26:27], v8 offset:1024
v_mfma_f32_32x32x16_bf16 v[184:199], v[68:71], v[28:31], v[184:199]
ds_read_b64_tr_b16 v[28:29], v9 offset:0
ds_read_b64_tr_b16 v[30:31], v9 offset:1024
ds_read_b128 v[36:39], v3 offset:0
s_waitcnt lgkmcnt(5)
v_mfma_f32_32x32x16_bf16 v[72:87], v[32:35], v[16:19], 0
ds_read_b64_tr_b16 v[16:17], v6 offset:4096
ds_read_b64_tr_b16 v[18:19], v6 offset:5120
v_mfma_f32_32x32x16_bf16 v[88:103], v[32:35], v[20:23], 0
ds_read_b64_tr_b16 v[20:21], v7 offset:4096
ds_read_b64_tr_b16 v[22:23], v7 offset:5120
v_cvt_pk_bf16_f32 v200, v168, v169
v_cvt_pk_bf16_f32 v201, v170, v171
s_waitcnt lgkmcnt(5)
v_mfma_f32_32x32x16_bf16 v[104:119], v[32:35], v[24:27], 0
ds_read_b64_tr_b16 v[24:25], v8 offset:4096
ds_read_b64_tr_b16 v[26:27], v8 offset:5120
v_cvt_pk_bf16_f32 v202, v172, v173
v_cvt_pk_bf16_f32 v203, v174, v175
v_mfma_f32_32x32x16_bf16 v[120:135], v[32:35], v[28:31], 0
ds_read_b64_tr_b16 v[28:29], v9 offset:4096
ds_read_b64_tr_b16 v[30:31], v9 offset:5120
v_cvt_pk_bf16_f32 v204, v176, v177
v_cvt_pk_bf16_f32 v205, v178, v179
ds_read_b128 v[32:35], v4 offset:0
s_waitcnt lgkmcnt(5)
v_mfma_f32_32x32x16_bf16 v[72:87], v[36:39], v[16:19], v[72:87]
ds_read_b64_tr_b16 v[16:17], v6 offset:8192
ds_read_b64_tr_b16 v[18:19], v6 offset:9216
v_cvt_pk_bf16_f32 v206, v180, v181
v_cvt_pk_bf16_f32 v207, v182, v183
v_mfma_f32_32x32x16_bf16 v[40:55], v[200:203], v[232:235], 0
v_cvt_pk_bf16_f32 v208, v184, v185
v_cvt_pk_bf16_f32 v209, v186, v187
v_cvt_pk_bf16_f32 v210, v188, v189
v_cvt_pk_bf16_f32 v211, v190, v191
v_cvt_pk_bf16_f32 v212, v192, v193
v_cvt_pk_bf16_f32 v213, v194, v195
v_mfma_f32_32x32x16_bf16 v[88:103], v[36:39], v[20:23], v[88:103]
ds_read_b64_tr_b16 v[20:21], v7 offset:8192
ds_read_b64_tr_b16 v[22:23], v7 offset:9216
v_cvt_pk_bf16_f32 v214, v196, v197
v_cvt_pk_bf16_f32 v215, v198, v199
v_mfma_f32_32x32x16_bf16 v[40:55], v[204:207], v[236:239], v[40:55]
v_mfma_f32_32x32x16_bf16 v[56:71], v[208:211], v[232:235], 0
v_mfma_f32_32x32x16_bf16 v[56:71], v[212:215], v[236:239], v[56:71]
v_mfma_f32_32x32x16_bf16 v[168:183], v[216:219], v[232:235], 0
s_waitcnt lgkmcnt(5)
v_mfma_f32_32x32x16_bf16 v[104:119], v[36:39], v[24:27], v[104:119]
ds_read_b64_tr_b16 v[24:25], v8 offset:8192
ds_read_b64_tr_b16 v[26:27], v8 offset:9216
v_mfma_f32_32x32x16_bf16 v[120:135], v[36:39], v[28:31], v[120:135]
ds_read_b64_tr_b16 v[28:29], v9 offset:8192
ds_read_b64_tr_b16 v[30:31], v9 offset:9216
ds_read_b128 v[36:39], v5 offset:0
s_waitcnt lgkmcnt(5)
v_mfma_f32_32x32x16_bf16 v[72:87], v[32:35], v[16:19], v[72:87]
ds_read_b64_tr_b16 v[16:17], v6 offset:12288
ds_read_b64_tr_b16 v[18:19], v6 offset:13312
v_add_u32 v6, 32768, v6
v_add_u32 v2, 32768, v2
v_mfma_f32_32x32x16_bf16 v[88:103], v[32:35], v[20:23], v[88:103]
ds_read_b64_tr_b16 v[20:21], v7 offset:12288
ds_read_b64_tr_b16 v[22:23], v7 offset:13312
v_add_u32 v7, 32768, v7
v_add_u32 v3, 32768, v3
s_waitcnt lgkmcnt(5)
v_mfma_f32_32x32x16_bf16 v[104:119], v[32:35], v[24:27], v[104:119]
ds_read_b64_tr_b16 v[24:25], v8 offset:12288
ds_read_b64_tr_b16 v[26:27], v8 offset:13312
v_add_u32 v8, 32768, v8
v_add_u32 v4, 32768, v4
v_mfma_f32_32x32x16_bf16 v[120:135], v[32:35], v[28:31], v[120:135]
ds_read_b64_tr_b16 v[28:29], v9 offset:12288
ds_read_b64_tr_b16 v[30:31], v9 offset:13312
v_add_u32 v9, 32768, v9
v_add_u32 v5, 32768, v5
s_waitcnt lgkmcnt(4)
v_mfma_f32_32x32x16_bf16 v[72:87], v[36:39], v[16:19], v[72:87]
v_cvt_pk_bf16_f32 v40, v40, v41
v_cvt_pk_bf16_f32 v41, v42, v43
v_cvt_pk_bf16_f32 v42, v44, v45
v_cvt_pk_bf16_f32 v43, v46, v47
v_cvt_pk_bf16_f32 v44, v48, v49
v_cvt_pk_bf16_f32 v45, v50, v51
v_cvt_pk_bf16_f32 v46, v52, v53
v_cvt_pk_bf16_f32 v47, v54, v55
ds_write_b128 v13, v[40:43] offset:0
ds_write_b128 v13, v[44:47] offset:1024
v_mfma_f32_32x32x16_bf16 v[168:183], v[220:223], v[236:239], v[168:183]
v_cvt_pk_bf16_f32 v56, v56, v57
v_cvt_pk_bf16_f32 v57, v58, v59
v_cvt_pk_bf16_f32 v58, v60, v61
v_cvt_pk_bf16_f32 v59, v62, v63
v_cvt_pk_bf16_f32 v60, v64, v65
v_cvt_pk_bf16_f32 v61, v66, v67
v_cvt_pk_bf16_f32 v62, v68, v69
v_cvt_pk_bf16_f32 v63, v70, v71
ds_write_b128 v13, v[56:59] offset:2048
ds_write_b128 v13, v[60:63] offset:3072
s_waitcnt lgkmcnt(0)
s_barrier
ds_read_b128 v[32:35], v2 offset:0
ds_read_b64_tr_b16 v[16:17], v6 offset:0
ds_read_b64_tr_b16 v[18:19], v6 offset:1024
v_mfma_f32_32x32x16_bf16 v[184:199], v[224:227], v[232:235], 0
v_mfma_f32_32x32x16_bf16 v[184:199], v[228:231], v[236:239], v[184:199]
v_mfma_f32_32x32x16_bf16 v[88:103], v[36:39], v[20:23], v[88:103]
ds_read_b64_tr_b16 v[20:21], v7 offset:0
ds_read_b64_tr_b16 v[22:23], v7 offset:1024
v_mfma_f32_32x32x16_bf16 v[104:119], v[36:39], v[24:27], v[104:119]
ds_read_b64_tr_b16 v[24:25], v8 offset:0
ds_read_b64_tr_b16 v[26:27], v8 offset:1024
v_mfma_f32_32x32x16_bf16 v[120:135], v[36:39], v[28:31], v[120:135]
ds_read_b64_tr_b16 v[28:29], v9 offset:0
ds_read_b64_tr_b16 v[30:31], v9 offset:1024
ds_read_b128 v[36:39], v3 offset:0
s_waitcnt lgkmcnt(5)
v_mfma_f32_32x32x16_bf16 v[72:87], v[32:35], v[16:19], v[72:87]
ds_read_b64_tr_b16 v[16:17], v6 offset:4096
ds_read_b64_tr_b16 v[18:19], v6 offset:5120
v_mfma_f32_32x32x16_bf16 v[88:103], v[32:35], v[20:23], v[88:103]
ds_read_b64_tr_b16 v[20:21], v7 offset:4096
ds_read_b64_tr_b16 v[22:23], v7 offset:5120
s_waitcnt lgkmcnt(5)
v_mfma_f32_32x32x16_bf16 v[104:119], v[32:35], v[24:27], v[104:119]
ds_read_b64_tr_b16 v[24:25], v8 offset:4096
ds_read_b64_tr_b16 v[26:27], v8 offset:5120
v_mfma_f32_32x32x16_bf16 v[120:135], v[32:35], v[28:31], v[120:135]
ds_read_b64_tr_b16 v[28:29], v9 offset:4096
ds_read_b64_tr_b16 v[30:31], v9 offset:5120
ds_read_b128 v[32:35], v4 offset:0
s_waitcnt lgkmcnt(5)
v_mfma_f32_32x32x16_bf16 v[72:87], v[36:39], v[16:19], v[72:87]
ds_read_b64_tr_b16 v[16:17], v6 offset:8192
ds_read_b64_tr_b16 v[18:19], v6 offset:9216
v_mfma_f32_32x32x16_bf16 v[88:103], v[36:39], v[20:23], v[88:103]
ds_read_b64_tr_b16 v[20:21], v7 offset:8192
ds_read_b64_tr_b16 v[22:23], v7 offset:9216
s_waitcnt lgkmcnt(5)
v_mfma_f32_32x32x16_bf16 v[104:119], v[36:39], v[24:27], v[104:119]
ds_read_b64_tr_b16 v[24:25], v8 offset:8192
ds_read_b64_tr_b16 v[26:27], v8 offset:9216
v_mfma_f32_32x32x16_bf16 v[120:135], v[36:39], v[28:31], v[120:135]
ds_read_b64_tr_b16 v[28:29], v9 offset:8192
ds_read_b64_tr_b16 v[30:31], v9 offset:9216
ds_read_b128 v[36:39], v5 offset:0
s_waitcnt lgkmcnt(5)
v_mfma_f32_32x32x16_bf16 v[72:87], v[32:35], v[16:19], v[72:87]
ds_read_b64_tr_b16 v[16:17], v6 offset:12288
ds_read_b64_tr_b16 v[18:19], v6 offset:13312
v_add_u32 v6, 32768, v6
v_add_u32 v2, 32768, v2
v_mfma_f32_32x32x16_bf16 v[88:103], v[32:35], v[20:23], v[88:103]
ds_read_b64_tr_b16 v[20:21], v7 offset:12288
ds_read_b64_tr_b16 v[22:23], v7 offset:13312
v_add_u32 v7, 32768, v7
v_add_u32 v3, 32768, v3
s_waitcnt lgkmcnt(5)
v_mfma_f32_32x32x16_bf16 v[104:119], v[32:35], v[24:27], v[104:119]
ds_read_b64_tr_b16 v[24:25], v8 offset:12288
ds_read_b64_tr_b16 v[26:27], v8 offset:13312
v_add_u32 v8, 32768, v8
v_add_u32 v4, 32768, v4
v_mfma_f32_32x32x16_bf16 v[120:135], v[32:35], v[28:31], v[120:135]
ds_read_b64_tr_b16 v[28:29], v9 offset:12288
ds_read_b64_tr_b16 v[30:31], v9 offset:13312
v_add_u32 v9, 32768, v9
v_add_u32 v5, 32768, v5
s_waitcnt lgkmcnt(4)
v_mfma_f32_32x32x16_bf16 v[72:87], v[36:39], v[16:19], v[72:87]
s_barrier
v_mfma_f32_32x32x16_bf16 v[88:103], v[36:39], v[20:23], v[88:103]
s_waitcnt lgkmcnt(0)
v_mfma_f32_32x32x16_bf16 v[104:119], v[36:39], v[24:27], v[104:119]
v_mfma_f32_32x32x16_bf16 v[120:135], v[36:39], v[28:31], v[120:135]
s_barrier
ds_read_b128 v[32:35], v2 offset:0
ds_read_b64_tr_b16 v[16:17], v10 offset:0
ds_read_b64_tr_b16 v[18:19], v10 offset:512
ds_read_b64_tr_b16 v[20:21], v11 offset:0
ds_read_b64_tr_b16 v[22:23], v11 offset:512
ds_read_b128 v[36:39], v3 offset:0
ds_read_b64_tr_b16 v[24:25], v10 offset:2048
ds_read_b64_tr_b16 v[26:27], v10 offset:2560
ds_read_b64_tr_b16 v[28:29], v11 offset:2048
ds_read_b64_tr_b16 v[30:31], v11 offset:2560
s_waitcnt lgkmcnt(5)
v_mfma_f32_32x32x16_bf16 v[200:215], v[32:35], v[16:19], 0
ds_read_b128 v[250:253], v4 offset:0
ds_read_b64_tr_b16 v[16:17], v10 offset:4096
ds_read_b64_tr_b16 v[18:19], v10 offset:4608
v_cvt_pk_bf16_f32 v56, v104, v105
v_cvt_pk_bf16_f32 v57, v106, v107
v_mfma_f32_32x32x16_bf16 v[216:231], v[32:35], v[20:23], 0
ds_read_b64_tr_b16 v[20:21], v11 offset:4096
ds_read_b64_tr_b16 v[22:23], v11 offset:4608
v_cvt_pk_bf16_f32 v58, v108, v109
v_cvt_pk_bf16_f32 v59, v110, v111
s_waitcnt lgkmcnt(5)
v_mfma_f32_32x32x16_bf16 v[200:215], v[36:39], v[24:27], v[200:215]
s_mul_i32 s44, s4, -65536
v_add_u32 v6, s44, v2
v_add_u32 v7, s44, v3
v_add_u32 v8, s44, v4
v_add_u32 v9, s44, v5
s_lshl_b32 s44, s9, 2
s_add_u32 s44, s44, 98304
v_mov_b32 v254, s44
s_lshl_b32 s54, s9, 1
s_sub_u32 s54, s7, s54
v_add_u32 v15, 98304, v12
ds_read_b128 v[32:35], v5 offset:0
ds_read_b64_tr_b16 v[24:25], v10 offset:6144
ds_read_b64_tr_b16 v[26:27], v10 offset:6656
v_cvt_pk_bf16_f32 v60, v112, v113
v_cvt_pk_bf16_f32 v61, v114, v115
v_mfma_f32_32x32x16_bf16 v[216:231], v[36:39], v[28:31], v[216:231]
ds_read_b64_tr_b16 v[28:29], v11 offset:6144
ds_read_b64_tr_b16 v[30:31], v11 offset:6656
v_cvt_pk_bf16_f32 v62, v116, v117
v_cvt_pk_bf16_f32 v63, v118, v119
s_waitcnt lgkmcnt(5)
v_mfma_f32_32x32x16_bf16 v[200:215], v[250:253], v[16:19], v[200:215]
ds_read_b128 v[36:39], v2 offset:16384
ds_read_b64_tr_b16 v[16:17], v10 offset:8192
ds_read_b64_tr_b16 v[18:19], v10 offset:8704
v_cvt_pk_bf16_f32 v64, v120, v121
v_cvt_pk_bf16_f32 v65, v122, v123
v_mfma_f32_32x32x16_bf16 v[216:231], v[250:253], v[20:23], v[216:231]
ds_read_b64_tr_b16 v[20:21], v11 offset:8192
ds_read_b64_tr_b16 v[22:23], v11 offset:8704
v_cvt_pk_bf16_f32 v66, v124, v125
v_cvt_pk_bf16_f32 v67, v126, v127
s_waitcnt lgkmcnt(5)
v_mfma_f32_32x32x16_bf16 v[200:215], v[32:35], v[24:27], v[200:215]
ds_read_b128 v[250:253], v3 offset:16384
ds_read_b64_tr_b16 v[24:25], v10 offset:10240
ds_read_b64_tr_b16 v[26:27], v10 offset:10752
v_cvt_pk_bf16_f32 v68, v128, v129
v_cvt_pk_bf16_f32 v69, v130, v131
v_mfma_f32_32x32x16_bf16 v[216:231], v[32:35], v[28:31], v[216:231]
ds_read_b64_tr_b16 v[28:29], v11 offset:10240
ds_read_b64_tr_b16 v[30:31], v11 offset:10752
v_cvt_pk_bf16_f32 v70, v132, v133
v_cvt_pk_bf16_f32 v71, v134, v135
s_waitcnt lgkmcnt(5)
v_mfma_f32_32x32x16_bf16 v[200:215], v[36:39], v[16:19], v[200:215]
ds_read_b128 v[32:35], v4 offset:16384
ds_read_b64_tr_b16 v[16:17], v10 offset:12288
ds_read_b64_tr_b16 v[18:19], v10 offset:12800
v_cvt_pk_bf16_f32 v40, v72, v73
v_cvt_pk_bf16_f32 v41, v74, v75
v_mfma_f32_32x32x16_bf16 v[216:231], v[36:39], v[20:23], v[216:231]
ds_read_b64_tr_b16 v[20:21], v11 offset:12288
ds_read_b64_tr_b16 v[22:23], v11 offset:12800
v_cvt_pk_bf16_f32 v42, v76, v77
v_cvt_pk_bf16_f32 v43, v78, v79
s_waitcnt lgkmcnt(5)
v_mfma_f32_32x32x16_bf16 v[200:215], v[250:253], v[24:27], v[200:215]
s_branch L_pg2
.p2align 12
L_pgpad2:
s_branch L_pgret
L_pg2:
ds_read_b128 v[36:39], v5 offset:16384
ds_read_b64_tr_b16 v[24:25], v10 offset:14336
ds_read_b64_tr_b16 v[26:27], v10 offset:14848
v_cvt_pk_bf16_f32 v44, v80, v81
v_cvt_pk_bf16_f32 v45, v82, v83
v_mfma_f32_32x32x16_bf16 v[216:231], v[250:253], v[28:31], v[216:231]
ds_read_b64_tr_b16 v[28:29], v11 offset:14336
ds_read_b64_tr_b16 v[30:31], v11 offset:14848
v_cvt_pk_bf16_f32 v46, v84, v85
v_cvt_pk_bf16_f32 v47, v86, v87
s_waitcnt lgkmcnt(5)
v_mfma_f32_32x32x16_bf16 v[200:215], v[32:35], v[16:19], v[200:215]
s_barrier
ds_read_b128 v[240:243], v248 offset:16384
ds_read_b128 v[244:247], v248 offset:17408
ds_read_b128 v[232:235], v248 offset:24576
ds_read_b128 v[236:239], v248 offset:25600
ds_read_b32 v255, v248 offset:8192
ds_read_b128 v[250:253], v6 offset:0
ds_read_b64_tr_b16 v[16:17], v10 offset:16384
ds_read_b64_tr_b16 v[18:19], v10 offset:16896
v_cvt_pk_bf16_f32 v48, v88, v89
v_cvt_pk_bf16_f32 v49, v90, v91
v_mfma_f32_32x32x16_bf16 v[216:231], v[32:35], v[20:23], v[216:231]
ds_read_b64_tr_b16 v[20:21], v11 offset:16384
ds_read_b64_tr_b16 v[22:23], v11 offset:16896
v_cvt_pk_bf16_f32 v50, v92, v93
v_cvt_pk_bf16_f32 v51, v94, v95
s_waitcnt lgkmcnt(10)
v_mfma_f32_32x32x16_bf16 v[200:215], v[36:39], v[24:27], v[200:215]
ds_read_b128 v[32:35], v7 offset:0
ds_read_b64_tr_b16 v[24:25], v10 offset:18432
ds_read_b64_tr_b16 v[26:27], v10 offset:18944
v_cvt_pk_bf16_f32 v52, v96, v97
v_cvt_pk_bf16_f32 v53, v98, v99
v_mfma_f32_32x32x16_bf16 v[216:231], v[36:39], v[28:31], v[216:231]
ds_read_b64_tr_b16 v[28:29], v11 offset:18432
ds_read_b64_tr_b16 v[30:31], v11 offset:18944
v_cvt_pk_bf16_f32 v54, v100, v101
v_cvt_pk_bf16_f32 v55, v102, v103
s_waitcnt lgkmcnt(5)
v_mfma_f32_32x32x16_bf16 v[104:119], v[250:253], v[16:19], 0
ds_read_b128 v[36:39], v8 offset:0
ds_read_b64_tr_b16 v[16:17], v10 offset:20480
ds_read_b64_tr_b16 v[18:19], v10 offset:20992
v_cvt_pk_bf16_f32 v72, v200, v201
v_cvt_pk_bf16_f32 v73, v202, v203
v_mfma_f32_32x32x16_bf16 v[120:135], v[250:253], v[20:23], 0
ds_read_b64_tr_b16 v[20:21], v11 offset:20480
ds_read_b64_tr_b16 v[22:23], v11 offset:20992
v_cvt_pk_bf16_f32 v74, v204, v205
v_cvt_pk_bf16_f32 v75, v206, v207
s_waitcnt lgkmcnt(5)
v_mfma_f32_32x32x16_bf16 v[104:119], v[32:35], v[24:27], v[104:119]
ds_read_b128 v[250:253], v9 offset:0
ds_read_b64_tr_b16 v[24:25], v10 offset:22528
ds_read_b64_tr_b16 v[26:27], v10 offset:23040
v_cvt_pk_bf16_f32 v76, v208, v209
v_cvt_pk_bf16_f32 v77, v210, v211
v_mfma_f32_32x32x16_bf16 v[120:135], v[32:35], v[28:31], v[120:135]
ds_read_b64_tr_b16 v[28:29], v11 offset:22528
ds_read_b64_tr_b16 v[30:31], v11 offset:23040
v_cvt_pk_bf16_f32 v78, v212, v213
v_cvt_pk_bf16_f32 v79, v214, v215
v_mfma_f32_32x32x16_bf16 v[136:151], v[40:43], v[240:243], v[136:151]
v_mfma_f32_32x32x16_bf16 v[136:151], v[44:47], v[244:247], v[136:151]
v_cvt_pk_bf16_f32 v80, v216, v217
v_cvt_pk_bf16_f32 v81, v218, v219
v_cvt_pk_bf16_f32 v82, v220, v221
v_cvt_pk_bf16_f32 v83, v222, v223
v_cvt_pk_bf16_f32 v84, v224, v225
v_cvt_pk_bf16_f32 v85, v226, v227
s_waitcnt lgkmcnt(5)
v_mfma_f32_32x32x16_bf16 v[104:119], v[36:39], v[16:19], v[104:119]
ds_read_b128 v[32:35], v6 offset:16384
ds_read_b64_tr_b16 v[16:17], v10 offset:24576
ds_read_b64_tr_b16 v[18:19], v10 offset:25088
v_cvt_pk_bf16_f32 v86, v228, v229
v_cvt_pk_bf16_f32 v87, v230, v231
v_mfma_f32_32x32x16_bf16 v[152:167], v[48:51], v[240:243], v[152:167]
v_mfma_f32_32x32x16_bf16 v[152:167], v[52:55], v[244:247], v[152:167]
ds_read_b128 v[40:43], v248 offset:0
ds_read_b128 v[44:47], v248 offset:1024
v_mfma_f32_32x32x16_bf16 v[136:151], v[72:75], v[232:235], v[136:151]
v_mfma_f32_32x32x16_bf16 v[136:151], v[76:79], v[236:239], v[136:151]
v_mfma_f32_32x32x16_bf16 v[152:167], v[80:83], v[232:235], v[152:167]
v_mfma_f32_32x32x16_bf16 v[152:167], v[84:87], v[236:239], v[152:167]
v_readfirstlane_b32 s88, v255
v_and_b32 v48, 1, v0
v_bfe_u32 v255, v0, 2, 1
v_lshl_or_b32 v48, v255, 16, v48
v_lshrrev_b32 v255, 1, v0
v_xor_b32 v255, v255, v0
v_bfe_u32 v255, v255, 4, 1
v_bfe_u32 v49, v0, 1, 1
v_xor_b32 v49, 1, v49
v_lshl_or_b32 v49, v255, 16, v49
s_bfe_u32 s44, s88, 0x10003
s_bfe_u32 s45, s88, 0x10002
s_lshl_b32 s45, s45, 16
s_or_b32 s44, s44, s45
v_mov_b32 v50, s44
s_bfe_u32 s44, s88, 0x10001
s_and_b32 s45, s88, 1
s_lshl_b32 s45, s45, 16
s_or_b32 s44, s44, s45
v_mov_b32 v51, s44
v_mfma_f32_32x32x16_bf16 v[168:183], v[56:59], v[240:243], v[168:183]
v_mfma_f32_32x32x16_bf16 v[168:183], v[60:63], v[244:247], v[168:183]
v_mfma_f32_32x32x16_bf16 v[184:199], v[64:67], v[240:243], v[184:199]
v_mfma_f32_32x32x16_bf16 v[184:199], v[68:71], v[244:247], v[184:199]
v_mfma_f32_32x32x16_bf16 v[120:135], v[36:39], v[20:23], v[120:135]
ds_read_b64_tr_b16 v[20:21], v11 offset:24576
ds_read_b64_tr_b16 v[22:23], v11 offset:25088
s_waitcnt lgkmcnt(7)
v_mfma_f32_32x32x16_bf16 v[104:119], v[250:253], v[24:27], v[104:119]
ds_read_b128 v[36:39], v7 offset:16384
ds_read_b64_tr_b16 v[24:25], v10 offset:26624
ds_read_b64_tr_b16 v[26:27], v10 offset:27136
v_mfma_f32_32x32x16_bf16 v[120:135], v[250:253], v[28:31], v[120:135]
ds_read_b64_tr_b16 v[28:29], v11 offset:26624
ds_read_b64_tr_b16 v[30:31], v11 offset:27136
s_waitcnt lgkmcnt(5)
v_mfma_f32_32x32x16_bf16 v[104:119], v[32:35], v[16:19], v[104:119]
ds_read_b128 v[250:253], v8 offset:16384
ds_read_b64_tr_b16 v[16:17], v10 offset:28672
ds_read_b64_tr_b16 v[18:19], v10 offset:29184
v_mfma_f32_32x32x16_bf16 v[120:135], v[32:35], v[20:23], v[120:135]
ds_read_b64_tr_b16 v[20:21], v11 offset:28672
ds_read_b64_tr_b16 v[22:23], v11 offset:29184
s_waitcnt lgkmcnt(5)
v_mfma_f32_32x32x16_bf16 v[104:119], v[36:39], v[24:27], v[104:119]
ds_read_b128 v[32:35], v9 offset:16384
ds_read_b64_tr_b16 v[24:25], v10 offset:30720
ds_read_b64_tr_b16 v[26:27], v10 offset:31232
v_mfma_f32_32x32x16_bf16 v[120:135], v[36:39], v[28:31], v[120:135]
ds_read_b64_tr_b16 v[28:29], v11 offset:30720
ds_read_b64_tr_b16 v[30:31], v11 offset:31232
s_waitcnt lgkmcnt(5)
v_mfma_f32_32x32x16_bf16 v[104:119], v[250:253], v[16:19], v[104:119]
v_subrev_u32 v10, 65536, v10
v_subrev_u32 v11, 65536, v11
s_barrier
ds_read_b128 v[36:39], v2 offset:0
ds_read_b64_tr_b16 v[16:17], v10 offset:0
ds_read_b64_tr_b16 v[18:19], v10 offset:512
v_mfma_f32_32x32x16_bf16 v[120:135], v[250:253], v[20:23], v[120:135]
ds_read_b64_tr_b16 v[20:21], v11 offset:0
ds_read_b64_tr_b16 v[22:23], v11 offset:512
s_waitcnt lgkmcnt(5)
v_mfma_f32_32x32x16_bf16 v[104:119], v[32:35], v[24:27], v[104:119]
ds_read_b128 v[250:253], v3 offset:0
ds_read_b64_tr_b16 v[24:25], v10 offset:2048
ds_read_b64_tr_b16 v[26:27], v10 offset:2560
v_mfma_f32_32x32x16_bf16 v[120:135], v[32:35], v[28:31], v[120:135]
ds_read_b64_tr_b16 v[28:29], v11 offset:2048
ds_read_b64_tr_b16 v[30:31], v11 offset:2560
s_waitcnt lgkmcnt(5)
v_mfma_f32_32x32x16_bf16 v[72:87], v[36:39], v[16:19], 0
s_barrier
ds_read_b128 v[32:35], v4 offset:0
ds_read_b64_tr_b16 v[16:17], v10 offset:4096
ds_read_b64_tr_b16 v[18:19], v10 offset:4608
v_cvt_pk_bf16_f32 v200, v104, v105
v_cvt_pk_bf16_f32 v201, v106, v107
v_mfma_f32_32x32x16_bf16 v[88:103], v[36:39], v[20:23], 0
ds_read_b64_tr_b16 v[20:21], v11 offset:4096
ds_read_b64_tr_b16 v[22:23], v11 offset:4608
v_cvt_pk_bf16_f32 v202, v108, v109
v_cvt_pk_bf16_f32 v203, v110, v111
s_waitcnt lgkmcnt(5)
v_mfma_f32_32x32x16_bf16 v[72:87], v[250:253], v[24:27], v[72:87]
ds_read_b128 v[36:39], v5 offset:0
ds_read_b64_tr_b16 v[24:25], v10 offset:6144
ds_read_b64_tr_b16 v[26:27], v10 offset:6656
v_cvt_pk_bf16_f32 v204, v112, v113
v_cvt_pk_bf16_f32 v205, v114, v115
v_mfma_f32_32x32x16_bf16 v[88:103], v[250:253], v[28:31], v[88:103]
ds_read_b64_tr_b16 v[28:29], v11 offset:6144
ds_read_b64_tr_b16 v[30:31], v11 offset:6656
v_cvt_pk_bf16_f32 v206, v116, v117
v_cvt_pk_bf16_f32 v207, v118, v119
v_mfma_f32_32x32x16_bf16 v[136:151], v[200:203], v[40:43], v[136:151]
s_waitcnt lgkmcnt(5)
v_mfma_f32_32x32x16_bf16 v[72:87], v[32:35], v[16:19], v[72:87]
ds_read_b128 v[250:253], v2 offset:16384
ds_read_b64_tr_b16 v[16:17], v10 offset:8192
ds_read_b64_tr_b16 v[18:19], v10 offset:8704
v_mfma_f32_32x32x16_bf16 v[136:151], v[204:207], v[44:47], v[136:151]
v_cvt_pk_bf16_f32 v208, v120, v121
v_cvt_pk_bf16_f32 v209, v122, v123
v_cvt_pk_bf16_f32 v210, v124, v125
v_cvt_pk_bf16_f32 v211, v126, v127
v_cvt_pk_bf16_f32 v212, v128, v129
v_cvt_pk_bf16_f32 v213, v130, v131
v_mfma_f32_32x32x16_bf16 v[88:103], v[32:35], v[20:23], v[88:103]
ds_read_b64_tr_b16 v[20:21], v11 offset:8192
ds_read_b64_tr_b16 v[22:23], v11 offset:8704
v_cvt_pk_bf16_f32 v214, v132, v133
v_cvt_pk_bf16_f32 v215, v134, v135
v_mfma_f32_32x32x16_bf16 v[152:167], v[208:211], v[40:43], v[152:167]
s_waitcnt lgkmcnt(5)
v_mfma_f32_32x32x16_bf16 v[72:87], v[36:39], v[24:27], v[72:87]
ds_read_b128 v[32:35], v3 offset:16384
ds_read_b64_tr_b16 v[24:25], v10 offset:10240
ds_read_b64_tr_b16 v[26:27], v10 offset:10752
v_mfma_f32_32x32x16_bf16 v[152:167], v[212:215], v[44:47], v[152:167]
v_cvt_pk_bf16_f32 v216, v136, v137
v_cvt_pk_bf16_f32 v217, v138, v139
v_cvt_pk_bf16_f32 v218, v140, v141
v_cvt_pk_bf16_f32 v219, v142, v143
v_cvt_pk_bf16_f32 v220, v144, v145
v_cvt_pk_bf16_f32 v221, v146, v147
v_mfma_f32_32x32x16_bf16 v[88:103], v[36:39], v[28:31], v[88:103]
ds_read_b64_tr_b16 v[28:29], v11 offset:10240
ds_read_b64_tr_b16 v[30:31], v11 offset:10752
v_cvt_pk_bf16_f32 v222, v148, v149
v_cvt_pk_bf16_f32 v223, v150, v151
s_waitcnt lgkmcnt(5)
v_mfma_f32_32x32x16_bf16 v[72:87], v[250:253], v[16:19], v[72:87]
ds_read_b128 v[36:39], v4 offset:16384
ds_read_b64_tr_b16 v[16:17], v10 offset:12288
ds_read_b64_tr_b16 v[18:19], v10 offset:12800
v_bfi_b32 v216, v249, v48, v216
v_bfi_b32 v217, v249, v49, v217
v_mfma_f32_32x32x16_bf16 v[88:103], v[250:253], v[20:23], v[88:103]
ds_read_b64_tr_b16 v[20:21], v11 offset:12288
ds_read_b64_tr_b16 v[22:23], v11 offset:12800
v_bfi_b32 v218, v249, v50, v218
v_bfi_b32 v219, v249, v51, v219
s_waitcnt lgkmcnt(5)
v_mfma_f32_32x32x16_bf16 v[72:87], v[32:35], v[24:27], v[72:87]
ds_read_b128 v[250:253], v5 offset:16384
ds_read_b64_tr_b16 v[24:25], v10 offset:14336
ds_read_b64_tr_b16 v[26:27], v10 offset:14848
v_bfi_b32 v220, v249, v48, v220
v_bfi_b32 v221, v249, v49, v221
v_mfma_f32_32x32x16_bf16 v[88:103], v[32:35], v[28:31], v[88:103]
ds_read_b64_tr_b16 v[28:29], v11 offset:14336
ds_read_b64_tr_b16 v[30:31], v11 offset:14848
v_bfi_b32 v222, v249, v50, v222
v_bfi_b32 v223, v249, v51, v223
s_waitcnt lgkmcnt(5)
v_mfma_f32_32x32x16_bf16 v[72:87], v[36:39], v[16:19], v[72:87]
ds_read_b128 v[32:35], v6 offset:0
ds_read_b64_tr_b16 v[16:17], v10 offset:16384
ds_read_b64_tr_b16 v[18:19], v10 offset:16896
s_cmp_eq_u32 s54, 0
s_cbranch_scc1 L_self0
s_add_u32 s44, s51, 0
buffer_store_dwordx4 v[216:219], v12, s[40:43], s44 offen sc1
s_add_u32 s44, s51, 8192
buffer_store_dwordx4 v[220:223], v12, s[40:43], s44 offen sc1
s_branch L_selfe0
L_self0:
ds_write_b128 v15, v[216:219] offset:4096
ds_write_b128 v15, v[220:223] offset:5120
s_waitcnt lgkmcnt(0)
L_selfe0:
v_mfma_f32_32x32x16_bf16 v[88:103], v[36:39], v[20:23], v[88:103]
ds_read_b128 v[36:39], v7 offset:0
ds_read_b64_tr_b16 v[20:21], v10 offset:18432
ds_read_b64_tr_b16 v[22:23], v10 offset:18944
v_cvt_pk_bf16_f32 v224, v152, v153
v_cvt_pk_bf16_f32 v225, v154, v155
s_waitcnt lgkmcnt(6)
v_mfma_f32_32x32x16_bf16 v[72:87], v[250:253], v[24:27], v[72:87]
ds_read_b128 v[56:59], v8 offset:0
ds_read_b64_tr_b16 v[24:25], v10 offset:20480
ds_read_b64_tr_b16 v[26:27], v10 offset:20992
v_cvt_pk_bf16_f32 v226, v156, v157
v_cvt_pk_bf16_f32 v227, v158, v159
v_mfma_f32_32x32x16_bf16 v[88:103], v[250:253], v[28:31], v[88:103]
ds_read_b128 v[60:63], v9 offset:0
ds_read_b64_tr_b16 v[28:29], v10 offset:22528
ds_read_b64_tr_b16 v[30:31], v10 offset:23040
v_cvt_pk_bf16_f32 v228, v160, v161
v_cvt_pk_bf16_f32 v229, v162, v163
s_waitcnt lgkmcnt(6)
v_mfma_f32_32x32x16_bf16 v[104:119], v[32:35], v[16:19], 0
ds_read_b128 v[250:253], v6 offset:16384
ds_read_b64_tr_b16 v[16:17], v10 offset:24576
ds_read_b64_tr_b16 v[18:19], v10 offset:25088
v_cvt_pk_bf16_f32 v230, v164, v165
v_cvt_pk_bf16_f32 v231, v166, v167
v_mfma_f32_32x32x16_bf16 v[104:119], v[36:39], v[20:23], v[104:119]
ds_read_b128 v[32:35], v7 offset:16384
ds_read_b64_tr_b16 v[20:21], v10 offset:26624
ds_read_b64_tr_b16 v[22:23], v10 offset:27136
v_bfi_b32 v224, v249, v48, v224
v_bfi_b32 v225, v249, v49, v225
s_waitcnt lgkmcnt(6)
v_mfma_f32_32x32x16_bf16 v[104:119], v[56:59], v[24:27], v[104:119]
ds_read_b128 v[36:39], v8 offset:16384
ds_read_b64_tr_b16 v[24:25], v10 offset:28672
ds_read_b64_tr_b16 v[26:27], v10 offset:29184
v_bfi_b32 v226, v249, v50, v226
v_bfi_b32 v227, v249, v51, v227
v_mfma_f32_32x32x16_bf16 v[104:119], v[60:63], v[28:31], v[104:119]
ds_read_b128 v[56:59], v9 offset:16384
ds_read_b64_tr_b16 v[28:29], v10 offset:30720
ds_read_b64_tr_b16 v[30:31], v10 offset:31232
v_bfi_b32 v228, v249, v48, v228
v_bfi_b32 v229, v249, v49, v229
s_waitcnt lgkmcnt(6)
v_mfma_f32_32x32x16_bf16 v[104:119], v[250:253], v[16:19], v[104:119]
v_bfi_b32 v230, v249, v50, v230
v_bfi_b32 v231, v249, v51, v231
s_cmp_eq_u32 s54, 1
s_cbranch_scc1 L_self1
s_add_u32 s44, s51, 32768
buffer_store_dwordx4 v[224:227], v12, s[40:43], s44 offen sc1
s_add_u32 s44, s51, 40960
buffer_store_dwordx4 v[228:231], v12, s[40:43], s44 offen sc1
s_branch L_selfe1
L_self1:
ds_write_b128 v15, v[224:227] offset:4096
ds_write_b128 v15, v[228:231] offset:5120
s_waitcnt lgkmcnt(0)
L_selfe1:
v_mov_b32 v255, 1
ds_write_b32 v254, v255 offset:0
ds_read_b128 v[60:63], v6 offset:0
ds_read_b64_tr_b16 v[16:17], v11 offset:16384
ds_read_b64_tr_b16 v[18:19], v11 offset:16896
v_cvt_pk_bf16_f32 v200, v72, v73
v_cvt_pk_bf16_f32 v201, v74, v75
v_mfma_f32_32x32x16_bf16 v[104:119], v[32:35], v[20:23], v[104:119]
ds_read_b128 v[250:253], v7 offset:0
ds_read_b64_tr_b16 v[20:21], v11 offset:18432
ds_read_b64_tr_b16 v[22:23], v11 offset:18944
v_cvt_pk_bf16_f32 v202, v76, v77
v_cvt_pk_bf16_f32 v203, v78, v79
s_waitcnt lgkmcnt(7)
v_mfma_f32_32x32x16_bf16 v[104:119], v[36:39], v[24:27], v[104:119]
ds_read_b128 v[32:35], v8 offset:0
ds_read_b64_tr_b16 v[24:25], v11 offset:20480
ds_read_b64_tr_b16 v[26:27], v11 offset:20992
v_cvt_pk_bf16_f32 v204, v80, v81
v_cvt_pk_bf16_f32 v205, v82, v83
v_mfma_f32_32x32x16_bf16 v[104:119], v[56:59], v[28:31], v[104:119]
ds_read_b128 v[36:39], v9 offset:0
ds_read_b64_tr_b16 v[28:29], v11 offset:22528
ds_read_b64_tr_b16 v[30:31], v11 offset:23040
v_cvt_pk_bf16_f32 v206, v84, v85
v_cvt_pk_bf16_f32 v207, v86, v87
v_mfma_f32_32x32x16_bf16 v[168:183], v[200:203], v[232:235], v[168:183]
s_waitcnt lgkmcnt(6)
v_mfma_f32_32x32x16_bf16 v[120:135], v[60:63], v[16:19], 0
ds_read_b128 v[56:59], v6 offset:16384
ds_read_b64_tr_b16 v[16:17], v11 offset:24576
ds_read_b64_tr_b16 v[18:19], v11 offset:25088
v_mfma_f32_32x32x16_bf16 v[168:183], v[204:207], v[236:239], v[168:183]
v_cvt_pk_bf16_f32 v208, v88, v89
v_cvt_pk_bf16_f32 v209, v90, v91
v_cvt_pk_bf16_f32 v210, v92, v93
v_cvt_pk_bf16_f32 v211, v94, v95
v_cvt_pk_bf16_f32 v212, v96, v97
v_cvt_pk_bf16_f32 v213, v98, v99
v_mfma_f32_32x32x16_bf16 v[120:135], v[250:253], v[20:23], v[120:135]
ds_read_b128 v[60:63], v7 offset:16384
ds_read_b64_tr_b16 v[20:21], v11 offset:26624
ds_read_b64_tr_b16 v[22:23], v11 offset:27136
v_cvt_pk_bf16_f32 v214, v100, v101
v_cvt_pk_bf16_f32 v215, v102, v103
v_mfma_f32_32x32x16_bf16 v[184:199], v[208:211], v[232:235], v[184:199]
s_waitcnt lgkmcnt(6)
v_mfma_f32_32x32x16_bf16 v[120:135], v[32:35], v[24:27], v[120:135]
ds_read_b128 v[250:253], v8 offset:16384
ds_read_b64_tr_b16 v[24:25], v11 offset:28672
ds_read_b64_tr_b16 v[26:27], v11 offset:29184
v_mfma_f32_32x32x16_bf16 v[184:199], v[212:215], v[236:239], v[184:199]
v_cvt_pk_bf16_f32 v200, v104, v105
v_cvt_pk_bf16_f32 v201, v106, v107
v_cvt_pk_bf16_f32 v202, v108, v109
v_cvt_pk_bf16_f32 v203, v110, v111
v_cvt_pk_bf16_f32 v204, v112, v113
v_cvt_pk_bf16_f32 v205, v114, v115
v_mfma_f32_32x32x16_bf16 v[120:135], v[36:39], v[28:31], v[120:135]
ds_read_b128 v[32:35], v9 offset:16384
ds_read_b64_tr_b16 v[28:29], v11 offset:30720
ds_read_b64_tr_b16 v[30:31], v11 offset:31232
v_cvt_pk_bf16_f32 v206, v116, v117
v_cvt_pk_bf16_f32 v207, v118, v119
v_mfma_f32_32x32x16_bf16 v[168:183], v[200:203], v[40:43], v[168:183]
s_waitcnt lgkmcnt(6)
v_mfma_f32_32x32x16_bf16 v[120:135], v[56:59], v[16:19], v[120:135]
v_mfma_f32_32x32x16_bf16 v[168:183], v[204:207], v[44:47], v[168:183]
v_mfma_f32_32x32x16_bf16 v[120:135], v[60:63], v[20:23], v[120:135]
s_waitcnt lgkmcnt(0)
v_mfma_f32_32x32x16_bf16 v[120:135], v[250:253], v[24:27], v[120:135]
v_mfma_f32_32x32x16_bf16 v[120:135], v[32:35], v[28:31], v[120:135]
s_nop 7
v_cvt_pk_bf16_f32 v72, v168, v169
v_cvt_pk_bf16_f32 v73, v170, v171
v_cvt_pk_bf16_f32 v74, v172, v173
v_cvt_pk_bf16_f32 v75, v174, v175
v_cvt_pk_bf16_f32 v76, v176, v177
v_cvt_pk_bf16_f32 v77, v178, v179
v_cvt_pk_bf16_f32 v78, v180, v181
v_cvt_pk_bf16_f32 v79, v182, v183
v_bfi_b32 v72, v249, v48, v72
v_bfi_b32 v73, v249, v49, v73
v_bfi_b32 v74, v249, v50, v74
v_bfi_b32 v75, v249, v51, v75
v_bfi_b32 v76, v249, v48, v76
v_bfi_b32 v77, v249, v49, v77
v_bfi_b32 v78, v249, v50, v78
v_bfi_b32 v79, v249, v51, v79
s_cmp_eq_u32 s54, 0
s_cbranch_scc1 L_self2
s_add_u32 s44, s51, 16384
buffer_store_dwordx4 v[72:75], v12, s[40:43], s44 offen sc1
s_add_u32 s44, s51, 24576
buffer_store_dwordx4 v[76:79], v12, s[40:43], s44 offen sc1
s_branch L_selfe2
L_self2:
ds_write_b128 v15, v[72:75] offset:6144
ds_write_b128 v15, v[76:79] offset:7168
s_waitcnt lgkmcnt(0)
L_selfe2:
v_cvt_pk_bf16_f32 v208, v120, v121
v_cvt_pk_bf16_f32 v209, v122, v123
v_cvt_pk_bf16_f32 v210, v124, v125
v_cvt_pk_bf16_f32 v211, v126, v127
v_cvt_pk_bf16_f32 v212, v128, v129
v_cvt_pk_bf16_f32 v213, v130, v131
v_cvt_pk_bf16_f32 v214, v132, v133
v_cvt_pk_bf16_f32 v215, v134, v135
v_mfma_f32_32x32x16_bf16 v[184:199], v[208:211], v[40:43], v[184:199]
s_nop 0
v_mfma_f32_32x32x16_bf16 v[184:199], v[212:215], v[44:47], v[184:199]
s_nop 11
v_cvt_pk_bf16_f32 v80, v184, v185
v_cvt_pk_bf16_f32 v81, v186, v187
v_cvt_pk_bf16_f32 v82, v188, v189
v_cvt_pk_bf16_f32 v83, v190, v191
v_cvt_pk_bf16_f32 v84, v192, v193
v_cvt_pk_bf16_f32 v85, v194, v195
v_cvt_pk_bf16_f32 v86, v196, v197
v_cvt_pk_bf16_f32 v87, v198, v199
v_bfi_b32 v80, v249, v48, v80
v_bfi_b32 v81, v249, v49, v81
v_bfi_b32 v82, v249, v50, v82
v_bfi_b32 v83, v249, v51, v83
v_bfi_b32 v84, v249, v48, v84
v_bfi_b32 v85, v249, v49, v85
v_bfi_b32 v86, v249, v50, v86
v_bfi_b32 v87, v249, v51, v87
s_cmp_eq_u32 s54, 1
s_cbranch_scc1 L_self3
s_add_u32 s44, s51, 49152
buffer_store_dwordx4 v[80:83], v12, s[40:43], s44 offen sc1
s_add_u32 s44, s51, 57344
buffer_store_dwordx4 v[84:87], v12, s[40:43], s44 offen sc1
s_branch L_selfe3
L_self3:
ds_write_b128 v15, v[80:83] offset:6144
ds_write_b128 v15, v[84:87] offset:7168
s_waitcnt lgkmcnt(0)
L_selfe3:
v_mov_b32 v255, 2
ds_write_b32 v254, v255 offset:0
s_waitcnt vmcnt(0)
v_mov_b32 v255, 3
ds_write_b32 v254, v255 offset:0
L_end:
s_endpgm
.section .rodata,"a"
.p2align 6
.amdhsa_kernel concat_heads__gqa_block_cached__mha_block_cached__near_ridge_kernel
  .amdhsa_next_free_vgpr 256
  .amdhsa_next_free_sgpr 102
  .amdhsa_accum_offset 256
  .amdhsa_group_segment_fixed_size 0
  .amdhsa_kernarg_size 104
  .amdhsa_user_sgpr_count 2
  .amdhsa_user_sgpr_kernarg_segment_ptr 1
  .amdhsa_system_sgpr_workgroup_id_x 1
  .amdhsa_float_denorm_mode_32 3
.end_amdhsa_kernel
```
